```python
import torch

def _softmax(x, axis=-1):
    return torch.softmax(x, dim=axis)
def _gelu(x):
    return torch.nn.functional.gelu(x, approximate="tanh")
def _silu(x):
    return torch.nn.functional.silu(x)
def _sigmoid(x):
    return torch.sigmoid(x)
def _layernorm(x, axis=-1, eps=1e-5):
    m = x.mean(dim=axis, keepdim=True)
    v = x.var(dim=axis, keepdim=True, unbiased=False)
    return (x - m) / torch.sqrt(v + eps)
def _scatter_add(tgt, idx, src, axis=0):
    return tgt.clone().index_add_(axis, idx, src)
def _segment_sum(src, seg, n):
    out = torch.zeros((n,) + src.shape[1:], dtype=src.dtype)
    return out.index_add_(0, seg, src)
def _pad(x, pw):
    flat = tuple(v for pair in reversed(pw) for v in pair)
    return torch.nn.functional.pad(x, flat)

kernel_name = 'standalone__paged_block_table_kv_radixattention__sampling'

def setup_inputs():

    _w = (lambda a: (lambda t: t.to(torch.bfloat16) if t.is_floating_point() else t)(torch.as_tensor(a)))
    B, H, Hkv, Dh = 32, 16, 8, 256
    Lk = 2048
    bs = 16
    nb = max(2, Lk // bs)
    P = max(1, nb // 2)
    n_phys = P + B * (nb - P)
    shared = torch.arange(P, dtype=torch.int64)
    priv = P + torch.arange(B * (nb - P), dtype=torch.int64).reshape(B, nb - P)
    bt = torch.cat([torch.tile(shared[None, :], (B, 1)), priv], dim=1)
    ctx = nb * bs - (torch.arange(1, B + 1, dtype=torch.int64) * 2654435761) % max(1, (nb * bs - P * bs) // 2)
    return {
        "q": _w((lambda *s: torch.randn(*s, dtype=torch.bfloat16) * 0.8)(B, H, Dh)),
        "k_cache": _w((lambda *s: torch.randn(*s, dtype=torch.bfloat16) * 0.8)(n_phys, bs, Hkv, Dh)),
        "v_cache": _w((lambda *s: torch.randn(*s, dtype=torch.bfloat16) * 0.05)(n_phys, bs, Hkv, Dh)),
        "block_table": _w(bt.to(torch.int64)),
        "ctx_lens": _w(torch.as_tensor(ctx).to(torch.int64)),
    }

def reference(q, k_cache, v_cache, block_table, ctx_lens):
    B, H, Dh = q.shape
    n_phys, bs, Hkv, _ = k_cache.shape
    nb = block_table.shape[1]
    Lk = nb * bs
    rep = H // Hkv
    k = k_cache[block_table].reshape(B, Lk, Hkv, Dh)
    v = v_cache[block_table].reshape(B, Lk, Hkv, Dh)
    k = (lambda x, n, axis: torch.repeat_interleave(x, n, dim=axis))(k, rep, axis=2)
    v = (lambda x, n, axis: torch.repeat_interleave(x, n, dim=axis))(v, rep, axis=2)
    scores = torch.einsum("bhd,bkhd->bhk", q, k) * (Dh ** -0.5)
    pos = torch.arange(Lk)
    valid = pos[None, :] < ctx_lens[:, None]
    scores = torch.where(valid[:, None, :], scores, -1e9)
    p = _softmax(scores, axis=-1)
    return torch.einsum("bhk,bkhd->bhd", p, v)
```

```asm
; @launch kernel=standalone__paged_block_table_kv_radixattention__sampling_kernel grid=(256,1,1) block=(512,1,1) lds=21760
; @launch kernel=combine_kernel grid=(128,1,1) block=(256,1,1) lds=0
.amdgcn_target "amdgcn-amd-amdhsa--gfx950"
.text
.globl standalone__paged_block_table_kv_radixattention__sampling_kernel
.p2align 8
.type standalone__paged_block_table_kv_radixattention__sampling_kernel,@function
standalone__paged_block_table_kv_radixattention__sampling_kernel:
  s_cmp_ge_u32 s2, 256
  s_cbranch_scc1 L_main_end
  s_load_dwordx16 s[16:31], s[0:1], 0
  v_and_b32 v8, 63, v0
  v_lshrrev_b32 v12, 6, v0
  v_and_b32 v9, 15, v0
  v_readfirstlane_b32 s32, v12
  v_lshrrev_b32 v10, 4, v8
  s_lshr_b32 s43, s2, 3
  s_and_b32 s33, s2, 7
  s_lshl_b32 s36, s33, 9
  s_mov_b32 s52, 0x3db8aa3b
  s_mov_b32 s53, 0x05040100
  s_mov_b32 s54, 0x07060302
  v_and_b32 v12, 31, v8
  v_lshlrev_b32 v14, 2, v12
  v_lshlrev_b32 v12, 4, v12
  v_lshrrev_b32 v13, 5, v8
  v_lshl_add_u32 v13, v13, 9, v12
  s_mov_b32 s57, 4096
  s_mov_b32 s58, 8192
  s_mov_b32 s92, 12288
  s_cmp_eq_u32 s32, 7
  s_cselect_b32 s34, 1, 0
  s_waitcnt lgkmcnt(0)
  global_load_dword v16, v14, s[24:25]
  s_mov_b32 s12, s22
  s_and_b32 s13, s23, 0xffff
  s_mov_b32 s14, 16384
  s_mov_b32 s15, 0x00020000
  s_mov_b32 s4, s18
  s_and_b32 s5, s19, 0xffff
  s_mov_b32 s6, 138412032
  s_mov_b32 s7, 0x00020000
  s_mov_b32 s8, s20
  s_and_b32 s9, s21, 0xffff
  s_mov_b32 s10, 138412032
  s_mov_b32 s11, 0x00020000
  buffer_load_dwordx4 v[188:191], v12, s[12:15], 0 offen
  buffer_load_dwordx4 v[124:127], v13, s[12:15], 0 offen offset:0
  buffer_load_dwordx4 v[128:131], v13, s[12:15], 0 offen offset:1024
  buffer_load_dwordx4 v[132:135], v13, s[12:15], 0 offen offset:2048
  buffer_load_dwordx4 v[136:139], v13, s[12:15], 0 offen offset:3072
  buffer_load_dwordx4 v[140:143], v13, s[12:15], s57 offen offset:0
  buffer_load_dwordx4 v[144:147], v13, s[12:15], s57 offen offset:1024
  buffer_load_dwordx4 v[148:151], v13, s[12:15], s57 offen offset:2048
  buffer_load_dwordx4 v[152:155], v13, s[12:15], s57 offen offset:3072
  buffer_load_dwordx4 v[156:159], v13, s[12:15], s58 offen offset:0
  buffer_load_dwordx4 v[160:163], v13, s[12:15], s58 offen offset:1024
  buffer_load_dwordx4 v[164:167], v13, s[12:15], s58 offen offset:2048
  buffer_load_dwordx4 v[168:171], v13, s[12:15], s58 offen offset:3072
  buffer_load_dwordx4 v[172:175], v13, s[12:15], s92 offen offset:0
  buffer_load_dwordx4 v[176:179], v13, s[12:15], s92 offen offset:1024
  buffer_load_dwordx4 v[180:183], v13, s[12:15], s92 offen offset:2048
  buffer_load_dwordx4 v[184:187], v13, s[12:15], s92 offen offset:3072
  v_lshlrev_b32 v1, 12, v9
  v_lshl_add_u32 v1, v10, 4, v1
  v_lshlrev_b32 v2, 14, v10
  v_lshl_add_u32 v2, v9, 4, v2
  v_mov_b32 v6, 0xff800000
  v_mov_b32 v7, 0
  s_waitcnt vmcnt(17)
  v_max_i32 v16, 0, v16
  v_min_i32 v16, 2048, v16
  s_cmp_eq_u32 s34, 1
  s_cbranch_scc1 L_pro_shared
  s_lshr_b32 s80, s43, 1
  s_and_b32 s79, s43, 1
  v_and_b32 v15, 31, v8
  v_sub_u32 v15, 31, v15
  v_lshl_add_u32 v17, v16, 5, v15
  ds_write_b32 v14, v17 offset:7168
  v_lshrrev_b32 v15, 5, v8
  v_lshlrev_b32 v15, 6, v15
  v_mov_b32 v18, 0
  s_waitcnt lgkmcnt(0)
  ds_read_b128 v[28:31], v15 offset:7168
  ds_read_b128 v[32:35], v15 offset:7184
  ds_read_b128 v[36:39], v15 offset:7200
  ds_read_b128 v[40:43], v15 offset:7216
  s_waitcnt lgkmcnt(0)
  v_cmp_gt_u32 s[60:61], v28, v17
  v_cmp_gt_u32 s[62:63], v29, v17
  v_cmp_gt_u32 s[64:65], v30, v17
  v_cmp_gt_u32 s[66:67], v31, v17
  v_cmp_gt_u32 s[68:69], v32, v17
  v_cmp_gt_u32 s[70:71], v33, v17
  v_cmp_gt_u32 s[72:73], v34, v17
  v_cmp_gt_u32 s[74:75], v35, v17
  s_nop 1
  v_addc_co_u32 v18, vcc, 0, v18, s[60:61]
  v_addc_co_u32 v18, vcc, 0, v18, s[62:63]
  v_addc_co_u32 v18, vcc, 0, v18, s[64:65]
  v_addc_co_u32 v18, vcc, 0, v18, s[66:67]
  v_addc_co_u32 v18, vcc, 0, v18, s[68:69]
  v_addc_co_u32 v18, vcc, 0, v18, s[70:71]
  v_addc_co_u32 v18, vcc, 0, v18, s[72:73]
  v_addc_co_u32 v18, vcc, 0, v18, s[74:75]
  v_cmp_gt_u32 s[60:61], v36, v17
  v_cmp_gt_u32 s[62:63], v37, v17
  v_cmp_gt_u32 s[64:65], v38, v17
  v_cmp_gt_u32 s[66:67], v39, v17
  v_cmp_gt_u32 s[68:69], v40, v17
  v_cmp_gt_u32 s[70:71], v41, v17
  v_cmp_gt_u32 s[72:73], v42, v17
  v_cmp_gt_u32 s[74:75], v43, v17
  s_nop 1
  v_addc_co_u32 v18, vcc, 0, v18, s[60:61]
  v_addc_co_u32 v18, vcc, 0, v18, s[62:63]
  v_addc_co_u32 v18, vcc, 0, v18, s[64:65]
  v_addc_co_u32 v18, vcc, 0, v18, s[66:67]
  v_addc_co_u32 v18, vcc, 0, v18, s[68:69]
  v_addc_co_u32 v18, vcc, 0, v18, s[70:71]
  v_addc_co_u32 v18, vcc, 0, v18, s[72:73]
  v_addc_co_u32 v18, vcc, 0, v18, s[74:75]
  v_mov_b32 v15, v18
  s_nop 1
  v_permlane32_swap_b32 v18, v15
  s_nop 1
  v_add_u32 v18, v18, v15
  s_sub_u32 s55, 31, s80
  v_cmp_eq_u32 s[60:61], s80, v18
  v_cmp_eq_u32 s[62:63], s55, v18
  s_nop 3
  s_ff1_i32_b32 s76, s60
  s_ff1_i32_b32 s77, s62
  v_readlane_b32 s81, v16, s76
  v_readlane_b32 s82, v16, s77
  s_waitcnt vmcnt(0)
  s_lshr_b32 s55, s76, 1
  s_lshl_b32 s56, s55, 2
  s_and_b32 s55, s76, 1
  s_cmp_eq_u32 s55, 0
  s_cselect_b64 vcc, -1, 0
  s_set_gpr_idx_on s56, gpr_idx(SRC0)
  s_nop 1
  v_mov_b32 v192, v124
  v_mov_b32 v193, v125
  v_mov_b32 v194, v126
  v_mov_b32 v195, v127
  s_nop 0
  s_set_gpr_idx_off
  s_nop 0
  v_mov_b32 v24, v192
  v_mov_b32 v25, v193
  v_mov_b32 v26, v194
  v_mov_b32 v27, v195
  s_nop 1
  v_permlane32_swap_b32 v192, v24
  v_permlane32_swap_b32 v193, v25
  v_permlane32_swap_b32 v194, v26
  v_permlane32_swap_b32 v195, v27
  s_nop 1
  v_cndmask_b32 v192, v24, v192, vcc
  v_cndmask_b32 v193, v25, v193, vcc
  v_cndmask_b32 v194, v26, v194, vcc
  v_cndmask_b32 v195, v27, v195, vcc
  s_lshr_b32 s55, s77, 1
  s_lshl_b32 s56, s55, 2
  s_and_b32 s55, s77, 1
  s_cmp_eq_u32 s55, 0
  s_cselect_b64 vcc, -1, 0
  s_set_gpr_idx_on s56, gpr_idx(SRC0)
  s_nop 1
  v_mov_b32 v196, v124
  v_mov_b32 v197, v125
  v_mov_b32 v198, v126
  v_mov_b32 v199, v127
  s_nop 0
  s_set_gpr_idx_off
  s_nop 0
  v_mov_b32 v24, v196
  v_mov_b32 v25, v197
  v_mov_b32 v26, v198
  v_mov_b32 v27, v199
  s_nop 1
  v_permlane32_swap_b32 v196, v24
  v_permlane32_swap_b32 v197, v25
  v_permlane32_swap_b32 v198, v26
  v_permlane32_swap_b32 v199, v27
  s_nop 1
  v_cndmask_b32 v196, v24, v196, vcc
  v_cndmask_b32 v197, v25, v197, vcc
  v_cndmask_b32 v198, v26, v198, vcc
  v_cndmask_b32 v199, v27, v199, vcc
  s_branch L_pro_common
L_pro_shared:
  s_lshr_b32 s93, s43, 2
  s_and_b32 s35, s43, 3
  s_add_u32 s94, s93, 2
  s_lshl_b32 s55, s35, 3
  s_mov_b32 s87, 0
  s_add_u32 s56, s55, 0
  v_readlane_b32 s57, v16, s56
  s_nop 3
  s_max_u32 s87, s87, s57
  s_add_u32 s56, s55, 1
  v_readlane_b32 s57, v16, s56
  s_nop 3
  s_max_u32 s87, s87, s57
  s_add_u32 s56, s55, 2
  v_readlane_b32 s57, v16, s56
  s_nop 3
  s_max_u32 s87, s87, s57
  s_add_u32 s56, s55, 3
  v_readlane_b32 s57, v16, s56
  s_nop 3
  s_max_u32 s87, s87, s57
  s_add_u32 s56, s55, 4
  v_readlane_b32 s57, v16, s56
  s_nop 3
  s_max_u32 s87, s87, s57
  s_add_u32 s56, s55, 5
  v_readlane_b32 s57, v16, s56
  s_nop 3
  s_max_u32 s87, s87, s57
  s_add_u32 s56, s55, 6
  v_readlane_b32 s57, v16, s56
  s_nop 3
  s_max_u32 s87, s87, s57
  s_add_u32 s56, s55, 7
  v_readlane_b32 s57, v16, s56
  s_nop 3
  s_max_u32 s87, s87, s57
  s_add_u32 s87, s87, 15
  s_lshr_b32 s87, s87, 4
  v_lshrrev_b32 v11, 1, v9
  v_add_u32 v11, s55, v11
  s_waitcnt vmcnt(0)
L_pro_common:
  v_xor_b32 v20, v124, v188
  v_xor_b32 v128, v128, v188
  v_xor_b32 v132, v132, v188
  v_xor_b32 v136, v136, v188
  v_xor_b32 v140, v140, v188
  v_xor_b32 v144, v144, v188
  v_xor_b32 v148, v148, v188
  v_xor_b32 v152, v152, v188
  v_xor_b32 v156, v156, v188
  v_xor_b32 v160, v160, v188
  v_xor_b32 v164, v164, v188
  v_xor_b32 v168, v168, v188
  v_xor_b32 v172, v172, v188
  v_xor_b32 v176, v176, v188
  v_xor_b32 v180, v180, v188
  v_xor_b32 v184, v184, v188
  v_or3_b32 v20, v20, v128, v132
  v_or3_b32 v20, v20, v136, v140
  v_or3_b32 v20, v20, v144, v148
  v_or3_b32 v20, v20, v152, v156
  v_or3_b32 v20, v20, v160, v164
  v_or3_b32 v20, v20, v168, v172
  v_or3_b32 v20, v20, v176, v180
  v_or_b32 v20, v20, v184
  v_xor_b32 v21, v125, v189
  v_xor_b32 v129, v129, v189
  v_xor_b32 v133, v133, v189
  v_xor_b32 v137, v137, v189
  v_xor_b32 v141, v141, v189
  v_xor_b32 v145, v145, v189
  v_xor_b32 v149, v149, v189
  v_xor_b32 v153, v153, v189
  v_xor_b32 v157, v157, v189
  v_xor_b32 v161, v161, v189
  v_xor_b32 v165, v165, v189
  v_xor_b32 v169, v169, v189
  v_xor_b32 v173, v173, v189
  v_xor_b32 v177, v177, v189
  v_xor_b32 v181, v181, v189
  v_xor_b32 v185, v185, v189
  v_or3_b32 v21, v21, v129, v133
  v_or3_b32 v21, v21, v137, v141
  v_or3_b32 v21, v21, v145, v149
  v_or3_b32 v21, v21, v153, v157
  v_or3_b32 v21, v21, v161, v165
  v_or3_b32 v21, v21, v169, v173
  v_or3_b32 v21, v21, v177, v181
  v_or_b32 v21, v21, v185
  v_xor_b32 v22, v126, v190
  v_xor_b32 v130, v130, v190
  v_xor_b32 v134, v134, v190
  v_xor_b32 v138, v138, v190
  v_xor_b32 v142, v142, v190
  v_xor_b32 v146, v146, v190
  v_xor_b32 v150, v150, v190
  v_xor_b32 v154, v154, v190
  v_xor_b32 v158, v158, v190
  v_xor_b32 v162, v162, v190
  v_xor_b32 v166, v166, v190
  v_xor_b32 v170, v170, v190
  v_xor_b32 v174, v174, v190
  v_xor_b32 v178, v178, v190
  v_xor_b32 v182, v182, v190
  v_xor_b32 v186, v186, v190
  v_or3_b32 v22, v22, v130, v134
  v_or3_b32 v22, v22, v138, v142
  v_or3_b32 v22, v22, v146, v150
  v_or3_b32 v22, v22, v154, v158
  v_or3_b32 v22, v22, v162, v166
  v_or3_b32 v22, v22, v170, v174
  v_or3_b32 v22, v22, v178, v182
  v_or_b32 v22, v22, v186
  v_xor_b32 v23, v127, v191
  v_xor_b32 v131, v131, v191
  v_xor_b32 v135, v135, v191
  v_xor_b32 v139, v139, v191
  v_xor_b32 v143, v143, v191
  v_xor_b32 v147, v147, v191
  v_xor_b32 v151, v151, v191
  v_xor_b32 v155, v155, v191
  v_xor_b32 v159, v159, v191
  v_xor_b32 v163, v163, v191
  v_xor_b32 v167, v167, v191
  v_xor_b32 v171, v171, v191
  v_xor_b32 v175, v175, v191
  v_xor_b32 v179, v179, v191
  v_xor_b32 v183, v183, v191
  v_xor_b32 v187, v187, v191
  v_or3_b32 v23, v23, v131, v135
  v_or3_b32 v23, v23, v139, v143
  v_or3_b32 v23, v23, v147, v151
  v_or3_b32 v23, v23, v155, v159
  v_or3_b32 v23, v23, v163, v167
  v_or3_b32 v23, v23, v171, v175
  v_or3_b32 v23, v23, v179, v183
  v_or_b32 v23, v23, v187
  v_cmp_ne_u32 s[60:61], 0, v20
  v_cmp_ne_u32 s[62:63], 0, v21
  v_cmp_ne_u32 s[64:65], 0, v22
  v_cmp_ne_u32 s[66:67], 0, v23
  v_and_b32 v124, 31, v8
  v_lshlrev_b32 v124, 2, v124
  v_add_u32 v125, 0, v124
  v_add_u32 v126, 1, v124
  v_add_u32 v127, 2, v124
  v_add_u32 v128, 3, v124
  s_or_b32 s88, s60, s61
  s_or_b32 s89, s62, s63
  s_or_b32 s90, s64, s65
  s_or_b32 s91, s66, s67
  s_cmp_eq_u32 s34, 1
  s_cbranch_scc1 L_pro_shared2
  s_add_u32 s81, s81, 15
  s_lshr_b32 s81, s81, 4
  s_mov_b32 s57, 0
  s_add_u32 s55, s81, 3
  s_lshr_b32 s55, s55, 2
  s_lshl_b64 s[60:61], 1, s55
  s_sub_u32 s60, s60, 1
  s_and_b32 s60, s60, s88
  s_bcnt1_i32_b32 s55, s60
  s_add_u32 s57, s57, s55
  s_add_u32 s55, s81, 2
  s_lshr_b32 s55, s55, 2
  s_lshl_b64 s[60:61], 1, s55
  s_sub_u32 s60, s60, 1
  s_and_b32 s60, s60, s89
  s_bcnt1_i32_b32 s55, s60
  s_add_u32 s57, s57, s55
  s_add_u32 s55, s81, 1
  s_lshr_b32 s55, s55, 2
  s_lshl_b64 s[60:61], 1, s55
  s_sub_u32 s60, s60, 1
  s_and_b32 s60, s60, s90
  s_bcnt1_i32_b32 s55, s60
  s_add_u32 s57, s57, s55
  s_add_u32 s55, s81, 0
  s_lshr_b32 s55, s55, 2
  s_lshl_b64 s[60:61], 1, s55
  s_sub_u32 s60, s60, 1
  s_and_b32 s60, s60, s91
  s_bcnt1_i32_b32 s55, s60
  s_add_u32 s57, s57, s55
  s_add_u32 s82, s82, 15
  s_lshr_b32 s82, s82, 4
  s_mov_b32 s58, 0
  s_add_u32 s55, s82, 3
  s_lshr_b32 s55, s55, 2
  s_lshl_b64 s[60:61], 1, s55
  s_sub_u32 s60, s60, 1
  s_and_b32 s60, s60, s88
  s_bcnt1_i32_b32 s55, s60
  s_add_u32 s58, s58, s55
  s_add_u32 s55, s82, 2
  s_lshr_b32 s55, s55, 2
  s_lshl_b64 s[60:61], 1, s55
  s_sub_u32 s60, s60, 1
  s_and_b32 s60, s60, s89
  s_bcnt1_i32_b32 s55, s60
  s_add_u32 s58, s58, s55
  s_add_u32 s55, s82, 1
  s_lshr_b32 s55, s55, 2
  s_lshl_b64 s[60:61], 1, s55
  s_sub_u32 s60, s60, 1
  s_and_b32 s60, s60, s90
  s_bcnt1_i32_b32 s55, s60
  s_add_u32 s58, s58, s55
  s_add_u32 s55, s82, 0
  s_lshr_b32 s55, s55, 2
  s_lshl_b64 s[60:61], 1, s55
  s_sub_u32 s60, s60, 1
  s_and_b32 s60, s60, s91
  s_bcnt1_i32_b32 s55, s60
  s_add_u32 s58, s58, s55
  s_add_u32 s57, s57, 1
  s_lshr_b32 s57, s57, 1
  s_add_u32 s58, s58, 1
  s_lshr_b32 s58, s58, 1
  s_add_u32 s60, s57, 1
  s_lshr_b32 s60, s60, 1
  s_lshr_b32 s61, s58, 1
  s_sub_u32 s62, s57, s60
  s_sub_u32 s63, s58, s61
  s_cmp_eq_u32 s79, 0
  s_cselect_b32 s64, s60, s62
  s_cselect_b32 s65, s61, s63
  s_cselect_b32 s66, 0, s60
  s_cselect_b32 s67, 0, s61
  s_add_u32 s55, s64, s65
  s_mul_i32 s56, s64, 14
  s_mov_b32 s78, 0
  s_mov_b32 s57, s55
  s_cmp_le_u32 s57, s56
  s_addc_u32 s78, s78, 0
  s_add_u32 s57, s57, s55
  s_add_u32 s57, s57, s55
  s_cmp_le_u32 s57, s56
  s_addc_u32 s78, s78, 0
  s_add_u32 s57, s57, s55
  s_add_u32 s57, s57, s55
  s_cmp_le_u32 s57, s56
  s_addc_u32 s78, s78, 0
  s_add_u32 s57, s57, s55
  s_add_u32 s57, s57, s55
  s_cmp_le_u32 s57, s56
  s_addc_u32 s78, s78, 0
  s_add_u32 s57, s57, s55
  s_add_u32 s57, s57, s55
  s_cmp_le_u32 s57, s56
  s_addc_u32 s78, s78, 0
  s_add_u32 s57, s57, s55
  s_add_u32 s57, s57, s55
  s_cmp_le_u32 s57, s56
  s_addc_u32 s78, s78, 0
  s_add_u32 s57, s57, s55
  s_add_u32 s57, s57, s55
  s_cmp_le_u32 s57, s56
  s_addc_u32 s78, s78, 0
  s_cmp_lg_u32 s64, 0
  s_cselect_b32 s57, 1, 0
  s_max_u32 s78, s78, s57
  s_cmp_lg_u32 s65, 0
  s_cselect_b32 s57, 6, 7
  s_min_u32 s78, s78, s57
  s_sub_u32 s55, s32, s78
  s_sub_u32 s56, 7, s78
  s_cmp_lt_u32 s32, s78
  s_cselect_b32 s43, s76, s77
  s_cselect_b32 s87, s81, s82
  s_cselect_b32 s37, s64, s65
  s_cselect_b32 s83, s66, s67
  s_cselect_b32 s38, s32, s55
  s_cselect_b32 s95, s78, s56
  s_cselect_b32 s59, 0, 1024
  s_cselect_b32 s3, 0, 1
  s_cselect_b64 vcc, -1, 0
  s_xor_b32 s3, s3, s33
  s_lshl_b32 s36, s3, 9
  v_mov_b32 v11, s43
  s_waitcnt vmcnt(0)
  v_cndmask_b32 v192, v196, v192, vcc
  v_cndmask_b32 v193, v197, v193, vcc
  v_cndmask_b32 v194, v198, v194, vcc
  v_cndmask_b32 v195, v199, v195, vcc
  s_mov_b32 s56, 0
  s_branch L_pro_common2
L_pro_shared2:
  v_mov_b32 v192, v188
  v_mov_b32 v193, v189
  v_mov_b32 v194, v190
  v_mov_b32 v195, v191
  s_mov_b32 s59, 2048
  s_mov_b32 s56, -1
  s_xor_b32 s3, s33, 1
  s_lshl_b32 s36, s3, 9
L_pro_common2:
  v_and_b32 v14, 1, v9
  v_lshl_add_u32 v14, v11, 4, v14
  s_lshl_b32 s55, s3, 1
  v_add_u32 v14, s55, v14
  v_lshlrev_b32 v15, 9, v14
  v_lshl_add_u32 v15, v10, 4, v15
  global_load_dwordx4 v[28:31], v15, s[16:17] offset:0
  global_load_dwordx4 v[32:35], v15, s[16:17] offset:64
  global_load_dwordx4 v[36:39], v15, s[16:17] offset:128
  global_load_dwordx4 v[40:43], v15, s[16:17] offset:192
  global_load_dwordx4 v[44:47], v15, s[16:17] offset:256
  global_load_dwordx4 v[48:51], v15, s[16:17] offset:320
  global_load_dwordx4 v[52:55], v15, s[16:17] offset:384
  global_load_dwordx4 v[56:59], v15, s[16:17] offset:448
  v_lshlrev_b32 v14, 2, v11
  ds_bpermute_b32 v5, v14, v16
  v_cmp_gt_u32 s[68:69], s87, v125
  v_cmp_gt_u32 s[70:71], s87, v126
  v_cmp_gt_u32 s[72:73], s87, v127
  v_cmp_gt_u32 s[74:75], s87, v128
  s_nop 3
  s_xor_b32 s88, s88, s56
  s_and_b32 s88, s88, s68
  s_xor_b32 s89, s89, s56
  s_and_b32 s89, s89, s70
  s_xor_b32 s90, s90, s56
  s_and_b32 s90, s90, s72
  s_xor_b32 s91, s91, s56
  s_and_b32 s91, s91, s74
  s_mov_b32 s86, 0
  v_mbcnt_lo_u32_b32 v12, s88, 0
  v_add_u32 v12, s86, v12
  v_lshlrev_b32 v12, 3, v12
  v_add_u32 v12, s59, v12
  v_mov_b32 v14, v192
  v_lshlrev_b32 v15, 4, v125
  s_mov_b32 exec_lo, s88
  s_mov_b32 exec_hi, 0
  ds_write_b64 v12, v[14:15]
  s_mov_b64 exec, -1
  s_bcnt1_i32_b32 s55, s88
  s_add_u32 s86, s86, s55
  v_mbcnt_lo_u32_b32 v12, s89, 0
  v_add_u32 v12, s86, v12
  v_lshlrev_b32 v12, 3, v12
  v_add_u32 v12, s59, v12
  v_mov_b32 v14, v193
  v_lshlrev_b32 v15, 4, v126
  s_mov_b32 exec_lo, s89
  s_mov_b32 exec_hi, 0
  ds_write_b64 v12, v[14:15]
  s_mov_b64 exec, -1
  s_bcnt1_i32_b32 s55, s89
  s_add_u32 s86, s86, s55
  v_mbcnt_lo_u32_b32 v12, s90, 0
  v_add_u32 v12, s86, v12
  v_lshlrev_b32 v12, 3, v12
  v_add_u32 v12, s59, v12
  v_mov_b32 v14, v194
  v_lshlrev_b32 v15, 4, v127
  s_mov_b32 exec_lo, s90
  s_mov_b32 exec_hi, 0
  ds_write_b64 v12, v[14:15]
  s_mov_b64 exec, -1
  s_bcnt1_i32_b32 s55, s90
  s_add_u32 s86, s86, s55
  v_mbcnt_lo_u32_b32 v12, s91, 0
  v_add_u32 v12, s86, v12
  v_lshlrev_b32 v12, 3, v12
  v_add_u32 v12, s59, v12
  v_mov_b32 v14, v195
  v_lshlrev_b32 v15, 4, v128
  s_mov_b32 exec_lo, s91
  s_mov_b32 exec_hi, 0
  ds_write_b64 v12, v[14:15]
  s_mov_b64 exec, -1
  s_bcnt1_i32_b32 s55, s91
  s_add_u32 s86, s86, s55
  s_cmp_eq_u32 s34, 0
  s_cbranch_scc1 L_pro_common3
  s_add_u32 s55, s86, 1
  s_lshr_b32 s55, s55, 1
  s_lshr_b32 s56, s55, 3
  s_and_b32 s57, s55, 7
  s_mul_i32 s83, s93, s56
  s_min_u32 s92, s93, s57
  s_add_u32 s83, s83, s92
  s_cmp_lt_u32 s93, s57
  s_cselect_b32 s92, 1, 0
  s_add_u32 s37, s56, s92
  s_mov_b32 s38, 0
  s_mov_b32 s95, 1
L_pro_common3:
  s_lshl_b32 s58, s83, 1
  v_add_u32 v12, s58, v8
  v_lshlrev_b32 v13, 3, v12
  v_and_b32 v13, 0x3ff, v13
  v_add_u32 v13, s59, v13
  s_waitcnt lgkmcnt(0)
  ds_read_b64 v[14:15], v13
  v_cmp_gt_u32 vcc, s86, v12
  v_mov_b32 v13, 0x100000
  v_mov_b32 v12, 2112
  s_waitcnt lgkmcnt(0)
  v_cndmask_b32 v3, v12, v14, vcc
  v_cndmask_b32 v4, v13, v15, vcc
  v_lshlrev_b32 v12, 2, v10
  v_sub_u32 v5, v5, v12
  s_cmp_ge_u32 s38, s37
  s_cbranch_scc1 L_zero_o
  s_cmp_eq_u32 s34, 1
  s_cbranch_scc1 L_path_sh
L_path_pr:
  s_lshl_b32 s55, s38, 1
  s_and_b32 s55, s55, 63
  s_add_u32 s56, s55, 1
  v_readlane_b32 s41, v3, s55
  v_readlane_b32 s42, v3, s56
  v_readlane_b32 s84, v4, s55
  v_readlane_b32 s85, v4, s56
  s_cmp_lt_u32 s38, s37
  s_nop 2
  s_cselect_b32 s41, s41, 2112
  s_cselect_b32 s42, s42, 2112
  s_lshl_b32 s41, s41, 16
  s_lshl_b32 s42, s42, 16
  s_add_u32 s41, s41, s36
  s_add_u32 s42, s42, s36
  s_mov_b32 s44, s41
  s_add_u32 s45, s41, 4096
  s_add_u32 s46, s41, 8192
  s_add_u32 s47, s41, 12288
  s_mov_b32 s48, s42
  s_add_u32 s49, s42, 4096
  s_add_u32 s50, s42, 8192
  s_add_u32 s51, s42, 12288
  buffer_load_dwordx4 v[124:127], v1, s[4:7], s41 offen offset:0 nt
  buffer_load_dwordx4 v[128:131], v1, s[4:7], s41 offen offset:64 nt
  buffer_load_dwordx4 v[132:135], v1, s[4:7], s41 offen offset:128 nt
  buffer_load_dwordx4 v[136:139], v1, s[4:7], s41 offen offset:192 nt
  buffer_load_dwordx4 v[140:143], v1, s[4:7], s41 offen offset:256 nt
  buffer_load_dwordx4 v[144:147], v1, s[4:7], s41 offen offset:320 nt
  buffer_load_dwordx4 v[148:151], v1, s[4:7], s41 offen offset:384 nt
  buffer_load_dwordx4 v[152:155], v1, s[4:7], s41 offen offset:448 nt
  buffer_load_dwordx4 v[156:159], v1, s[4:7], s42 offen offset:0 nt
  buffer_load_dwordx4 v[160:163], v1, s[4:7], s42 offen offset:64 nt
  buffer_load_dwordx4 v[164:167], v1, s[4:7], s42 offen offset:128 nt
  buffer_load_dwordx4 v[168:171], v1, s[4:7], s42 offen offset:192 nt
  buffer_load_dwordx4 v[172:175], v1, s[4:7], s42 offen offset:256 nt
  buffer_load_dwordx4 v[176:179], v1, s[4:7], s42 offen offset:320 nt
  buffer_load_dwordx4 v[180:183], v1, s[4:7], s42 offen offset:384 nt
  buffer_load_dwordx4 v[184:187], v1, s[4:7], s42 offen offset:448 nt
  buffer_load_dwordx4 v[188:191], v2, s[8:11], s44 offen offset:0 nt
  buffer_load_dwordx4 v[192:195], v2, s[8:11], s44 offen offset:256 nt
  buffer_load_dwordx4 v[196:199], v2, s[8:11], s45 offen offset:0 nt
  buffer_load_dwordx4 v[200:203], v2, s[8:11], s45 offen offset:256 nt
  buffer_load_dwordx4 v[204:207], v2, s[8:11], s46 offen offset:0 nt
  buffer_load_dwordx4 v[208:211], v2, s[8:11], s46 offen offset:256 nt
  buffer_load_dwordx4 v[212:215], v2, s[8:11], s47 offen offset:0 nt
  buffer_load_dwordx4 v[216:219], v2, s[8:11], s47 offen offset:256 nt
  buffer_load_dwordx4 v[220:223], v2, s[8:11], s48 offen offset:0 nt
  buffer_load_dwordx4 v[224:227], v2, s[8:11], s48 offen offset:256 nt
  buffer_load_dwordx4 v[228:231], v2, s[8:11], s49 offen offset:0 nt
  buffer_load_dwordx4 v[232:235], v2, s[8:11], s49 offen offset:256 nt
  buffer_load_dwordx4 v[236:239], v2, s[8:11], s50 offen offset:0 nt
  buffer_load_dwordx4 v[240:243], v2, s[8:11], s50 offen offset:256 nt
  buffer_load_dwordx4 v[244:247], v2, s[8:11], s51 offen offset:0 nt
  buffer_load_dwordx4 v[248:251], v2, s[8:11], s51 offen offset:256 nt
  s_mov_b32 s39, s84
  s_mov_b32 s40, s85
  v_mov_b32 v60, 0
  v_mov_b32 v61, 0
  v_mov_b32 v62, 0
  v_mov_b32 v63, 0
  v_mov_b32 v64, 0
  v_mov_b32 v65, 0
  v_mov_b32 v66, 0
  v_mov_b32 v67, 0
  v_mov_b32 v68, 0
  v_mov_b32 v69, 0
  v_mov_b32 v70, 0
  v_mov_b32 v71, 0
  v_mov_b32 v72, 0
  v_mov_b32 v73, 0
  v_mov_b32 v74, 0
  v_mov_b32 v75, 0
  v_mov_b32 v76, 0
  v_mov_b32 v77, 0
  v_mov_b32 v78, 0
  v_mov_b32 v79, 0
  v_mov_b32 v80, 0
  v_mov_b32 v81, 0
  v_mov_b32 v82, 0
  v_mov_b32 v83, 0
  v_mov_b32 v84, 0
  v_mov_b32 v85, 0
  v_mov_b32 v86, 0
  v_mov_b32 v87, 0
  v_mov_b32 v88, 0
  v_mov_b32 v89, 0
  v_mov_b32 v90, 0
  v_mov_b32 v91, 0
  v_mov_b32 v92, 0
  v_mov_b32 v93, 0
  v_mov_b32 v94, 0
  v_mov_b32 v95, 0
  v_mov_b32 v96, 0
  v_mov_b32 v97, 0
  v_mov_b32 v98, 0
  v_mov_b32 v99, 0
  v_mov_b32 v100, 0
  v_mov_b32 v101, 0
  v_mov_b32 v102, 0
  v_mov_b32 v103, 0
  v_mov_b32 v104, 0
  v_mov_b32 v105, 0
  v_mov_b32 v106, 0
  v_mov_b32 v107, 0
  v_mov_b32 v108, 0
  v_mov_b32 v109, 0
  v_mov_b32 v110, 0
  v_mov_b32 v111, 0
  v_mov_b32 v112, 0
  v_mov_b32 v113, 0
  v_mov_b32 v114, 0
  v_mov_b32 v115, 0
  v_mov_b32 v116, 0
  v_mov_b32 v117, 0
  v_mov_b32 v118, 0
  v_mov_b32 v119, 0
  v_mov_b32 v120, 0
  v_mov_b32 v121, 0
  v_mov_b32 v122, 0
  v_mov_b32 v123, 0
L_loop_pr:
  s_waitcnt vmcnt(16)
  v_mfma_f32_16x16x32_bf16 v[16:19], v[124:127], v[28:31], 0
  v_mfma_f32_16x16x32_bf16 v[20:23], v[156:159], v[28:31], 0
  v_mfma_f32_16x16x32_bf16 v[16:19], v[128:131], v[32:35], v[16:19]
  v_mfma_f32_16x16x32_bf16 v[20:23], v[160:163], v[32:35], v[20:23]
  v_mfma_f32_16x16x32_bf16 v[16:19], v[132:135], v[36:39], v[16:19]
  v_mfma_f32_16x16x32_bf16 v[20:23], v[164:167], v[36:39], v[20:23]
  v_mfma_f32_16x16x32_bf16 v[16:19], v[136:139], v[40:43], v[16:19]
  v_mfma_f32_16x16x32_bf16 v[20:23], v[168:171], v[40:43], v[20:23]
  v_mfma_f32_16x16x32_bf16 v[16:19], v[140:143], v[44:47], v[16:19]
  v_mfma_f32_16x16x32_bf16 v[20:23], v[172:175], v[44:47], v[20:23]
  v_mfma_f32_16x16x32_bf16 v[16:19], v[144:147], v[48:51], v[16:19]
  v_mfma_f32_16x16x32_bf16 v[20:23], v[176:179], v[48:51], v[20:23]
  v_mfma_f32_16x16x32_bf16 v[16:19], v[148:151], v[52:55], v[16:19]
  v_mfma_f32_16x16x32_bf16 v[20:23], v[180:183], v[52:55], v[20:23]
  v_mfma_f32_16x16x32_bf16 v[16:19], v[152:155], v[56:59], v[16:19]
  v_mfma_f32_16x16x32_bf16 v[20:23], v[184:187], v[56:59], v[20:23]
  s_add_u32 s38, s38, s95
  s_lshl_b32 s55, s38, 1
  s_and_b32 s55, s55, 63
  s_add_u32 s56, s55, 1
  v_readlane_b32 s41, v3, s55
  v_readlane_b32 s42, v3, s56
  v_readlane_b32 s84, v4, s55
  v_readlane_b32 s85, v4, s56
  s_cmp_lt_u32 s38, s37
  s_nop 2
  s_cselect_b32 s41, s41, 2112
  s_cselect_b32 s42, s42, 2112
  s_lshl_b32 s41, s41, 16
  s_lshl_b32 s42, s42, 16
  s_add_u32 s41, s41, s36
  s_add_u32 s42, s42, s36
  s_mov_b32 s44, s41
  s_add_u32 s45, s41, 4096
  s_add_u32 s46, s41, 8192
  s_add_u32 s47, s41, 12288
  s_mov_b32 s48, s42
  s_add_u32 s49, s42, 4096
  s_add_u32 s50, s42, 8192
  s_add_u32 s51, s42, 12288
  buffer_load_dwordx4 v[124:127], v1, s[4:7], s41 offen offset:0 nt
  buffer_load_dwordx4 v[128:131], v1, s[4:7], s41 offen offset:64 nt
  buffer_load_dwordx4 v[132:135], v1, s[4:7], s41 offen offset:128 nt
  buffer_load_dwordx4 v[136:139], v1, s[4:7], s41 offen offset:192 nt
  buffer_load_dwordx4 v[140:143], v1, s[4:7], s41 offen offset:256 nt
  buffer_load_dwordx4 v[144:147], v1, s[4:7], s41 offen offset:320 nt
  buffer_load_dwordx4 v[148:151], v1, s[4:7], s41 offen offset:384 nt
  buffer_load_dwordx4 v[152:155], v1, s[4:7], s41 offen offset:448 nt
  buffer_load_dwordx4 v[156:159], v1, s[4:7], s42 offen offset:0 nt
  buffer_load_dwordx4 v[160:163], v1, s[4:7], s42 offen offset:64 nt
  buffer_load_dwordx4 v[164:167], v1, s[4:7], s42 offen offset:128 nt
  buffer_load_dwordx4 v[168:171], v1, s[4:7], s42 offen offset:192 nt
  buffer_load_dwordx4 v[172:175], v1, s[4:7], s42 offen offset:256 nt
  buffer_load_dwordx4 v[176:179], v1, s[4:7], s42 offen offset:320 nt
  buffer_load_dwordx4 v[180:183], v1, s[4:7], s42 offen offset:384 nt
  buffer_load_dwordx4 v[184:187], v1, s[4:7], s42 offen offset:448 nt
  v_subrev_u32 v8, s39, v5
  v_subrev_u32 v9, s40, v5
  v_cmp_gt_i32 s[60:61], v8, 0
  v_cmp_gt_i32 s[62:63], v8, 1
  v_cmp_gt_i32 s[64:65], v8, 2
  v_cmp_gt_i32 s[66:67], v8, 3
  v_cmp_gt_i32 s[68:69], v9, 0
  v_cmp_gt_i32 s[70:71], v9, 1
  v_cmp_gt_i32 s[72:73], v9, 2
  v_cmp_gt_i32 s[74:75], v9, 3
  v_mov_b32 v10, 0xff800000
  s_nop 1
  v_cndmask_b32 v16, v10, v16, s[60:61]
  v_cndmask_b32 v17, v10, v17, s[62:63]
  v_cndmask_b32 v18, v10, v18, s[64:65]
  v_cndmask_b32 v19, v10, v19, s[66:67]
  v_cndmask_b32 v20, v10, v20, s[68:69]
  v_cndmask_b32 v21, v10, v21, s[70:71]
  v_cndmask_b32 v22, v10, v22, s[72:73]
  v_cndmask_b32 v23, v10, v23, s[74:75]
  v_max3_f32 v8, v16, v17, v18
  v_max3_f32 v9, v19, v20, v21
  v_max3_f32 v8, v22, v23, v8
  v_max_f32 v8, v8, v9
  v_mov_b32 v9, v8
  s_nop 1
  v_permlane32_swap_b32 v8, v9
  s_nop 1
  v_max_f32 v8, v8, v9
  v_mov_b32 v9, v8
  s_nop 1
  v_permlane16_swap_b32 v8, v9
  s_nop 1
  v_max_f32 v8, v8, v9
  v_max_f32 v8, v6, v8
  v_max_f32 v9, 0xff7fffff, v8
  v_mul_f32 v9, s52, v9
  v_fma_f32 v10, v6, s52, -v9
  v_exp_f32 v10, v10
  v_mov_b32 v6, v8
  v_fma_f32 v16, v16, s52, -v9
  v_fma_f32 v17, v17, s52, -v9
  v_fma_f32 v18, v18, s52, -v9
  v_fma_f32 v19, v19, s52, -v9
  v_fma_f32 v20, v20, s52, -v9
  v_fma_f32 v21, v21, s52, -v9
  v_fma_f32 v22, v22, s52, -v9
  v_fma_f32 v23, v23, s52, -v9
  v_exp_f32 v16, v16
  v_exp_f32 v17, v17
  v_exp_f32 v18, v18
  v_exp_f32 v19, v19
  v_exp_f32 v20, v20
  v_exp_f32 v21, v21
  v_exp_f32 v22, v22
  v_exp_f32 v23, v23
  v_cmp_neq_f32 vcc, 1.0, v10
  v_mul_f32 v7, v7, v10
  v_add_f32 v11, v16, v17
  v_add_f32 v12, v18, v19
  v_add_f32 v13, v20, v21
  v_add_f32 v14, v22, v23
  v_add_f32 v11, v11, v12
  v_add_f32 v13, v13, v14
  v_add_f32 v11, v11, v13
  v_add_f32 v7, v7, v11
  v_cvt_pk_bf16_f32 v24, v16, v17
  v_cvt_pk_bf16_f32 v25, v18, v19
  v_cvt_pk_bf16_f32 v26, v20, v21
  v_cvt_pk_bf16_f32 v27, v22, v23
  s_cbranch_vccz L_noscale_pr
  v_mul_f32 v60, v60, v10
  v_mul_f32 v61, v61, v10
  v_mul_f32 v62, v62, v10
  v_mul_f32 v63, v63, v10
  v_mul_f32 v64, v64, v10
  v_mul_f32 v65, v65, v10
  v_mul_f32 v66, v66, v10
  v_mul_f32 v67, v67, v10
  v_mul_f32 v68, v68, v10
  v_mul_f32 v69, v69, v10
  v_mul_f32 v70, v70, v10
  v_mul_f32 v71, v71, v10
  v_mul_f32 v72, v72, v10
  v_mul_f32 v73, v73, v10
  v_mul_f32 v74, v74, v10
  v_mul_f32 v75, v75, v10
  v_mul_f32 v76, v76, v10
  v_mul_f32 v77, v77, v10
  v_mul_f32 v78, v78, v10
  v_mul_f32 v79, v79, v10
  v_mul_f32 v80, v80, v10
  v_mul_f32 v81, v81, v10
  v_mul_f32 v82, v82, v10
  v_mul_f32 v83, v83, v10
  v_mul_f32 v84, v84, v10
  v_mul_f32 v85, v85, v10
  v_mul_f32 v86, v86, v10
  v_mul_f32 v87, v87, v10
  v_mul_f32 v88, v88, v10
  v_mul_f32 v89, v89, v10
  v_mul_f32 v90, v90, v10
  v_mul_f32 v91, v91, v10
  v_mul_f32 v92, v92, v10
  v_mul_f32 v93, v93, v10
  v_mul_f32 v94, v94, v10
  v_mul_f32 v95, v95, v10
  v_mul_f32 v96, v96, v10
  v_mul_f32 v97, v97, v10
  v_mul_f32 v98, v98, v10
  v_mul_f32 v99, v99, v10
  v_mul_f32 v100, v100, v10
  v_mul_f32 v101, v101, v10
  v_mul_f32 v102, v102, v10
  v_mul_f32 v103, v103, v10
  v_mul_f32 v104, v104, v10
  v_mul_f32 v105, v105, v10
  v_mul_f32 v106, v106, v10
  v_mul_f32 v107, v107, v10
  v_mul_f32 v108, v108, v10
  v_mul_f32 v109, v109, v10
  v_mul_f32 v110, v110, v10
  v_mul_f32 v111, v111, v10
  v_mul_f32 v112, v112, v10
  v_mul_f32 v113, v113, v10
  v_mul_f32 v114, v114, v10
  v_mul_f32 v115, v115, v10
  v_mul_f32 v116, v116, v10
  v_mul_f32 v117, v117, v10
  v_mul_f32 v118, v118, v10
  v_mul_f32 v119, v119, v10
  v_mul_f32 v120, v120, v10
  v_mul_f32 v121, v121, v10
  v_mul_f32 v122, v122, v10
  v_mul_f32 v123, v123, v10
L_noscale_pr:
  s_waitcnt vmcnt(16)
  v_perm_b32 v8, v196, v188, s53
  v_perm_b32 v9, v212, v204, s53
  v_perm_b32 v10, v228, v220, s53
  v_perm_b32 v11, v244, v236, s53
  s_nop 1
  v_mfma_f32_16x16x32_bf16 v[60:63], v[8:11], v[24:27], v[60:63]
  v_perm_b32 v12, v196, v188, s54
  v_perm_b32 v13, v212, v204, s54
  v_perm_b32 v14, v228, v220, s54
  v_perm_b32 v15, v244, v236, s54
  s_nop 1
  v_mfma_f32_16x16x32_bf16 v[64:67], v[12:15], v[24:27], v[64:67]
  v_perm_b32 v8, v197, v189, s53
  v_perm_b32 v9, v213, v205, s53
  v_perm_b32 v10, v229, v221, s53
  v_perm_b32 v11, v245, v237, s53
  s_nop 1
  v_mfma_f32_16x16x32_bf16 v[68:71], v[8:11], v[24:27], v[68:71]
  v_perm_b32 v12, v197, v189, s54
  v_perm_b32 v13, v213, v205, s54
  v_perm_b32 v14, v229, v221, s54
  v_perm_b32 v15, v245, v237, s54
  s_nop 1
  v_mfma_f32_16x16x32_bf16 v[72:75], v[12:15], v[24:27], v[72:75]
  v_perm_b32 v8, v198, v190, s53
  v_perm_b32 v9, v214, v206, s53
  v_perm_b32 v10, v230, v222, s53
  v_perm_b32 v11, v246, v238, s53
  s_nop 1
  v_mfma_f32_16x16x32_bf16 v[76:79], v[8:11], v[24:27], v[76:79]
  v_perm_b32 v12, v198, v190, s54
  v_perm_b32 v13, v214, v206, s54
  v_perm_b32 v14, v230, v222, s54
  v_perm_b32 v15, v246, v238, s54
  s_nop 1
  v_mfma_f32_16x16x32_bf16 v[80:83], v[12:15], v[24:27], v[80:83]
  v_perm_b32 v8, v199, v191, s53
  v_perm_b32 v9, v215, v207, s53
  v_perm_b32 v10, v231, v223, s53
  v_perm_b32 v11, v247, v239, s53
  s_nop 1
  v_mfma_f32_16x16x32_bf16 v[84:87], v[8:11], v[24:27], v[84:87]
  v_perm_b32 v12, v199, v191, s54
  v_perm_b32 v13, v215, v207, s54
  v_perm_b32 v14, v231, v223, s54
  v_perm_b32 v15, v247, v239, s54
  s_nop 1
  v_mfma_f32_16x16x32_bf16 v[88:91], v[12:15], v[24:27], v[88:91]
  v_perm_b32 v8, v200, v192, s53
  v_perm_b32 v9, v216, v208, s53
  v_perm_b32 v10, v232, v224, s53
  v_perm_b32 v11, v248, v240, s53
  s_nop 1
  v_mfma_f32_16x16x32_bf16 v[92:95], v[8:11], v[24:27], v[92:95]
  v_perm_b32 v12, v200, v192, s54
  v_perm_b32 v13, v216, v208, s54
  v_perm_b32 v14, v232, v224, s54
  v_perm_b32 v15, v248, v240, s54
  s_nop 1
  v_mfma_f32_16x16x32_bf16 v[96:99], v[12:15], v[24:27], v[96:99]
  v_perm_b32 v8, v201, v193, s53
  v_perm_b32 v9, v217, v209, s53
  v_perm_b32 v10, v233, v225, s53
  v_perm_b32 v11, v249, v241, s53
  s_nop 1
  v_mfma_f32_16x16x32_bf16 v[100:103], v[8:11], v[24:27], v[100:103]
  v_perm_b32 v12, v201, v193, s54
  v_perm_b32 v13, v217, v209, s54
  v_perm_b32 v14, v233, v225, s54
  v_perm_b32 v15, v249, v241, s54
  s_nop 1
  v_mfma_f32_16x16x32_bf16 v[104:107], v[12:15], v[24:27], v[104:107]
  v_perm_b32 v8, v202, v194, s53
  v_perm_b32 v9, v218, v210, s53
  v_perm_b32 v10, v234, v226, s53
  v_perm_b32 v11, v250, v242, s53
  s_nop 1
  v_mfma_f32_16x16x32_bf16 v[108:111], v[8:11], v[24:27], v[108:111]
  v_perm_b32 v12, v202, v194, s54
  v_perm_b32 v13, v218, v210, s54
  v_perm_b32 v14, v234, v226, s54
  v_perm_b32 v15, v250, v242, s54
  s_nop 1
  v_mfma_f32_16x16x32_bf16 v[112:115], v[12:15], v[24:27], v[112:115]
  v_perm_b32 v8, v203, v195, s53
  v_perm_b32 v9, v219, v211, s53
  v_perm_b32 v10, v235, v227, s53
  v_perm_b32 v11, v251, v243, s53
  s_nop 1
  v_mfma_f32_16x16x32_bf16 v[116:119], v[8:11], v[24:27], v[116:119]
  v_perm_b32 v12, v203, v195, s54
  v_perm_b32 v13, v219, v211, s54
  v_perm_b32 v14, v235, v227, s54
  v_perm_b32 v15, v251, v243, s54
  s_nop 1
  v_mfma_f32_16x16x32_bf16 v[120:123], v[12:15], v[24:27], v[120:123]
  buffer_load_dwordx4 v[188:191], v2, s[8:11], s44 offen offset:0 nt
  buffer_load_dwordx4 v[192:195], v2, s[8:11], s44 offen offset:256 nt
  buffer_load_dwordx4 v[196:199], v2, s[8:11], s45 offen offset:0 nt
  buffer_load_dwordx4 v[200:203], v2, s[8:11], s45 offen offset:256 nt
  buffer_load_dwordx4 v[204:207], v2, s[8:11], s46 offen offset:0 nt
  buffer_load_dwordx4 v[208:211], v2, s[8:11], s46 offen offset:256 nt
  buffer_load_dwordx4 v[212:215], v2, s[8:11], s47 offen offset:0 nt
  buffer_load_dwordx4 v[216:219], v2, s[8:11], s47 offen offset:256 nt
  buffer_load_dwordx4 v[220:223], v2, s[8:11], s48 offen offset:0 nt
  buffer_load_dwordx4 v[224:227], v2, s[8:11], s48 offen offset:256 nt
  buffer_load_dwordx4 v[228:231], v2, s[8:11], s49 offen offset:0 nt
  buffer_load_dwordx4 v[232:235], v2, s[8:11], s49 offen offset:256 nt
  buffer_load_dwordx4 v[236:239], v2, s[8:11], s50 offen offset:0 nt
  buffer_load_dwordx4 v[240:243], v2, s[8:11], s50 offen offset:256 nt
  buffer_load_dwordx4 v[244:247], v2, s[8:11], s51 offen offset:0 nt
  buffer_load_dwordx4 v[248:251], v2, s[8:11], s51 offen offset:256 nt
  s_mov_b32 s39, s84
  s_mov_b32 s40, s85
  s_cmp_lt_u32 s38, s37
  s_cbranch_scc1 L_loop_pr
  s_branch L_epilogue
L_path_sh:
  s_lshl_b32 s55, s38, 1
  s_and_b32 s55, s55, 63
  s_add_u32 s56, s55, 1
  v_readlane_b32 s41, v3, s55
  v_readlane_b32 s42, v3, s56
  v_readlane_b32 s84, v4, s55
  v_readlane_b32 s85, v4, s56
  s_cmp_lt_u32 s38, s37
  s_nop 2
  s_cselect_b32 s41, s41, 2112
  s_cselect_b32 s42, s42, 2112
  s_lshl_b32 s41, s41, 16
  s_lshl_b32 s42, s42, 16
  s_add_u32 s41, s41, s36
  s_add_u32 s42, s42, s36
  s_mov_b32 s44, s41
  s_add_u32 s45, s41, 4096
  s_add_u32 s46, s41, 8192
  s_add_u32 s47, s41, 12288
  s_mov_b32 s48, s42
  s_add_u32 s49, s42, 4096
  s_add_u32 s50, s42, 8192
  s_add_u32 s51, s42, 12288
  buffer_load_dwordx4 v[124:127], v1, s[4:7], s41 offen offset:0
  buffer_load_dwordx4 v[128:131], v1, s[4:7], s41 offen offset:64
  buffer_load_dwordx4 v[132:135], v1, s[4:7], s41 offen offset:128
  buffer_load_dwordx4 v[136:139], v1, s[4:7], s41 offen offset:192
  buffer_load_dwordx4 v[140:143], v1, s[4:7], s41 offen offset:256
  buffer_load_dwordx4 v[144:147], v1, s[4:7], s41 offen offset:320
  buffer_load_dwordx4 v[148:151], v1, s[4:7], s41 offen offset:384
  buffer_load_dwordx4 v[152:155], v1, s[4:7], s41 offen offset:448
  buffer_load_dwordx4 v[156:159], v1, s[4:7], s42 offen offset:0
  buffer_load_dwordx4 v[160:163], v1, s[4:7], s42 offen offset:64
  buffer_load_dwordx4 v[164:167], v1, s[4:7], s42 offen offset:128
  buffer_load_dwordx4 v[168:171], v1, s[4:7], s42 offen offset:192
  buffer_load_dwordx4 v[172:175], v1, s[4:7], s42 offen offset:256
  buffer_load_dwordx4 v[176:179], v1, s[4:7], s42 offen offset:320
  buffer_load_dwordx4 v[180:183], v1, s[4:7], s42 offen offset:384
  buffer_load_dwordx4 v[184:187], v1, s[4:7], s42 offen offset:448
  buffer_load_dwordx4 v[188:191], v2, s[8:11], s44 offen offset:0
  buffer_load_dwordx4 v[192:195], v2, s[8:11], s44 offen offset:256
  buffer_load_dwordx4 v[196:199], v2, s[8:11], s45 offen offset:0
  buffer_load_dwordx4 v[200:203], v2, s[8:11], s45 offen offset:256
  buffer_load_dwordx4 v[204:207], v2, s[8:11], s46 offen offset:0
  buffer_load_dwordx4 v[208:211], v2, s[8:11], s46 offen offset:256
  buffer_load_dwordx4 v[212:215], v2, s[8:11], s47 offen offset:0
  buffer_load_dwordx4 v[216:219], v2, s[8:11], s47 offen offset:256
  buffer_load_dwordx4 v[220:223], v2, s[8:11], s48 offen offset:0
  buffer_load_dwordx4 v[224:227], v2, s[8:11], s48 offen offset:256
  buffer_load_dwordx4 v[228:231], v2, s[8:11], s49 offen offset:0
  buffer_load_dwordx4 v[232:235], v2, s[8:11], s49 offen offset:256
  buffer_load_dwordx4 v[236:239], v2, s[8:11], s50 offen offset:0
  buffer_load_dwordx4 v[240:243], v2, s[8:11], s50 offen offset:256
  buffer_load_dwordx4 v[244:247], v2, s[8:11], s51 offen offset:0
  buffer_load_dwordx4 v[248:251], v2, s[8:11], s51 offen offset:256
  s_mov_b32 s39, s84
  s_mov_b32 s40, s85
  v_mov_b32 v60, 0
  v_mov_b32 v61, 0
  v_mov_b32 v62, 0
  v_mov_b32 v63, 0
  v_mov_b32 v64, 0
  v_mov_b32 v65, 0
  v_mov_b32 v66, 0
  v_mov_b32 v67, 0
  v_mov_b32 v68, 0
  v_mov_b32 v69, 0
  v_mov_b32 v70, 0
  v_mov_b32 v71, 0
  v_mov_b32 v72, 0
  v_mov_b32 v73, 0
  v_mov_b32 v74, 0
  v_mov_b32 v75, 0
  v_mov_b32 v76, 0
  v_mov_b32 v77, 0
  v_mov_b32 v78, 0
  v_mov_b32 v79, 0
  v_mov_b32 v80, 0
  v_mov_b32 v81, 0
  v_mov_b32 v82, 0
  v_mov_b32 v83, 0
  v_mov_b32 v84, 0
  v_mov_b32 v85, 0
  v_mov_b32 v86, 0
  v_mov_b32 v87, 0
  v_mov_b32 v88, 0
  v_mov_b32 v89, 0
  v_mov_b32 v90, 0
  v_mov_b32 v91, 0
  v_mov_b32 v92, 0
  v_mov_b32 v93, 0
  v_mov_b32 v94, 0
  v_mov_b32 v95, 0
  v_mov_b32 v96, 0
  v_mov_b32 v97, 0
  v_mov_b32 v98, 0
  v_mov_b32 v99, 0
  v_mov_b32 v100, 0
  v_mov_b32 v101, 0
  v_mov_b32 v102, 0
  v_mov_b32 v103, 0
  v_mov_b32 v104, 0
  v_mov_b32 v105, 0
  v_mov_b32 v106, 0
  v_mov_b32 v107, 0
  v_mov_b32 v108, 0
  v_mov_b32 v109, 0
  v_mov_b32 v110, 0
  v_mov_b32 v111, 0
  v_mov_b32 v112, 0
  v_mov_b32 v113, 0
  v_mov_b32 v114, 0
  v_mov_b32 v115, 0
  v_mov_b32 v116, 0
  v_mov_b32 v117, 0
  v_mov_b32 v118, 0
  v_mov_b32 v119, 0
  v_mov_b32 v120, 0
  v_mov_b32 v121, 0
  v_mov_b32 v122, 0
  v_mov_b32 v123, 0
L_loop_sh:
  s_waitcnt vmcnt(16)
  v_mfma_f32_16x16x32_bf16 v[16:19], v[124:127], v[28:31], 0
  v_mfma_f32_16x16x32_bf16 v[20:23], v[156:159], v[28:31], 0
  v_mfma_f32_16x16x32_bf16 v[16:19], v[128:131], v[32:35], v[16:19]
  v_mfma_f32_16x16x32_bf16 v[20:23], v[160:163], v[32:35], v[20:23]
  v_mfma_f32_16x16x32_bf16 v[16:19], v[132:135], v[36:39], v[16:19]
  v_mfma_f32_16x16x32_bf16 v[20:23], v[164:167], v[36:39], v[20:23]
  v_mfma_f32_16x16x32_bf16 v[16:19], v[136:139], v[40:43], v[16:19]
  v_mfma_f32_16x16x32_bf16 v[20:23], v[168:171], v[40:43], v[20:23]
  v_mfma_f32_16x16x32_bf16 v[16:19], v[140:143], v[44:47], v[16:19]
  v_mfma_f32_16x16x32_bf16 v[20:23], v[172:175], v[44:47], v[20:23]
  v_mfma_f32_16x16x32_bf16 v[16:19], v[144:147], v[48:51], v[16:19]
  v_mfma_f32_16x16x32_bf16 v[20:23], v[176:179], v[48:51], v[20:23]
  v_mfma_f32_16x16x32_bf16 v[16:19], v[148:151], v[52:55], v[16:19]
  v_mfma_f32_16x16x32_bf16 v[20:23], v[180:183], v[52:55], v[20:23]
  v_mfma_f32_16x16x32_bf16 v[16:19], v[152:155], v[56:59], v[16:19]
  v_mfma_f32_16x16x32_bf16 v[20:23], v[184:187], v[56:59], v[20:23]
  s_add_u32 s38, s38, s95
  s_lshl_b32 s55, s38, 1
  s_and_b32 s55, s55, 63
  s_add_u32 s56, s55, 1
  v_readlane_b32 s41, v3, s55
  v_readlane_b32 s42, v3, s56
  v_readlane_b32 s84, v4, s55
  v_readlane_b32 s85, v4, s56
  s_cmp_lt_u32 s38, s37
  s_nop 2
  s_cselect_b32 s41, s41, 2112
  s_cselect_b32 s42, s42, 2112
  s_lshl_b32 s41, s41, 16
  s_lshl_b32 s42, s42, 16
  s_add_u32 s41, s41, s36
  s_add_u32 s42, s42, s36
  s_mov_b32 s44, s41
  s_add_u32 s45, s41, 4096
  s_add_u32 s46, s41, 8192
  s_add_u32 s47, s41, 12288
  s_mov_b32 s48, s42
  s_add_u32 s49, s42, 4096
  s_add_u32 s50, s42, 8192
  s_add_u32 s51, s42, 12288
  buffer_load_dwordx4 v[124:127], v1, s[4:7], s41 offen offset:0
  buffer_load_dwordx4 v[128:131], v1, s[4:7], s41 offen offset:64
  buffer_load_dwordx4 v[132:135], v1, s[4:7], s41 offen offset:128
  buffer_load_dwordx4 v[136:139], v1, s[4:7], s41 offen offset:192
  buffer_load_dwordx4 v[140:143], v1, s[4:7], s41 offen offset:256
  buffer_load_dwordx4 v[144:147], v1, s[4:7], s41 offen offset:320
  buffer_load_dwordx4 v[148:151], v1, s[4:7], s41 offen offset:384
  buffer_load_dwordx4 v[152:155], v1, s[4:7], s41 offen offset:448
  buffer_load_dwordx4 v[156:159], v1, s[4:7], s42 offen offset:0
  buffer_load_dwordx4 v[160:163], v1, s[4:7], s42 offen offset:64
  buffer_load_dwordx4 v[164:167], v1, s[4:7], s42 offen offset:128
  buffer_load_dwordx4 v[168:171], v1, s[4:7], s42 offen offset:192
  buffer_load_dwordx4 v[172:175], v1, s[4:7], s42 offen offset:256
  buffer_load_dwordx4 v[176:179], v1, s[4:7], s42 offen offset:320
  buffer_load_dwordx4 v[180:183], v1, s[4:7], s42 offen offset:384
  buffer_load_dwordx4 v[184:187], v1, s[4:7], s42 offen offset:448
  v_subrev_u32 v8, s39, v5
  v_subrev_u32 v9, s40, v5
  v_cmp_gt_i32 s[60:61], v8, 0
  v_cmp_gt_i32 s[62:63], v8, 1
  v_cmp_gt_i32 s[64:65], v8, 2
  v_cmp_gt_i32 s[66:67], v8, 3
  v_cmp_gt_i32 s[68:69], v9, 0
  v_cmp_gt_i32 s[70:71], v9, 1
  v_cmp_gt_i32 s[72:73], v9, 2
  v_cmp_gt_i32 s[74:75], v9, 3
  v_mov_b32 v10, 0xff800000
  s_nop 1
  v_cndmask_b32 v16, v10, v16, s[60:61]
  v_cndmask_b32 v17, v10, v17, s[62:63]
  v_cndmask_b32 v18, v10, v18, s[64:65]
  v_cndmask_b32 v19, v10, v19, s[66:67]
  v_cndmask_b32 v20, v10, v20, s[68:69]
  v_cndmask_b32 v21, v10, v21, s[70:71]
  v_cndmask_b32 v22, v10, v22, s[72:73]
  v_cndmask_b32 v23, v10, v23, s[74:75]
  v_max3_f32 v8, v16, v17, v18
  v_max3_f32 v9, v19, v20, v21
  v_max3_f32 v8, v22, v23, v8
  v_max_f32 v8, v8, v9
  v_mov_b32 v9, v8
  s_nop 1
  v_permlane32_swap_b32 v8, v9
  s_nop 1
  v_max_f32 v8, v8, v9
  v_mov_b32 v9, v8
  s_nop 1
  v_permlane16_swap_b32 v8, v9
  s_nop 1
  v_max_f32 v8, v8, v9
  v_max_f32 v8, v6, v8
  v_max_f32 v9, 0xff7fffff, v8
  v_mul_f32 v9, s52, v9
  v_fma_f32 v10, v6, s52, -v9
  v_exp_f32 v10, v10
  v_mov_b32 v6, v8
  v_fma_f32 v16, v16, s52, -v9
  v_fma_f32 v17, v17, s52, -v9
  v_fma_f32 v18, v18, s52, -v9
  v_fma_f32 v19, v19, s52, -v9
  v_fma_f32 v20, v20, s52, -v9
  v_fma_f32 v21, v21, s52, -v9
  v_fma_f32 v22, v22, s52, -v9
  v_fma_f32 v23, v23, s52, -v9
  v_exp_f32 v16, v16
  v_exp_f32 v17, v17
  v_exp_f32 v18, v18
  v_exp_f32 v19, v19
  v_exp_f32 v20, v20
  v_exp_f32 v21, v21
  v_exp_f32 v22, v22
  v_exp_f32 v23, v23
  v_cmp_neq_f32 vcc, 1.0, v10
  v_mul_f32 v7, v7, v10
  v_add_f32 v11, v16, v17
  v_add_f32 v12, v18, v19
  v_add_f32 v13, v20, v21
  v_add_f32 v14, v22, v23
  v_add_f32 v11, v11, v12
  v_add_f32 v13, v13, v14
  v_add_f32 v11, v11, v13
  v_add_f32 v7, v7, v11
  v_cvt_pk_bf16_f32 v24, v16, v17
  v_cvt_pk_bf16_f32 v25, v18, v19
  v_cvt_pk_bf16_f32 v26, v20, v21
  v_cvt_pk_bf16_f32 v27, v22, v23
  s_cbranch_vccz L_noscale_sh
  v_mul_f32 v60, v60, v10
  v_mul_f32 v61, v61, v10
  v_mul_f32 v62, v62, v10
  v_mul_f32 v63, v63, v10
  v_mul_f32 v64, v64, v10
  v_mul_f32 v65, v65, v10
  v_mul_f32 v66, v66, v10
  v_mul_f32 v67, v67, v10
  v_mul_f32 v68, v68, v10
  v_mul_f32 v69, v69, v10
  v_mul_f32 v70, v70, v10
  v_mul_f32 v71, v71, v10
  v_mul_f32 v72, v72, v10
  v_mul_f32 v73, v73, v10
  v_mul_f32 v74, v74, v10
  v_mul_f32 v75, v75, v10
  v_mul_f32 v76, v76, v10
  v_mul_f32 v77, v77, v10
  v_mul_f32 v78, v78, v10
  v_mul_f32 v79, v79, v10
  v_mul_f32 v80, v80, v10
  v_mul_f32 v81, v81, v10
  v_mul_f32 v82, v82, v10
  v_mul_f32 v83, v83, v10
  v_mul_f32 v84, v84, v10
  v_mul_f32 v85, v85, v10
  v_mul_f32 v86, v86, v10
  v_mul_f32 v87, v87, v10
  v_mul_f32 v88, v88, v10
  v_mul_f32 v89, v89, v10
  v_mul_f32 v90, v90, v10
  v_mul_f32 v91, v91, v10
  v_mul_f32 v92, v92, v10
  v_mul_f32 v93, v93, v10
  v_mul_f32 v94, v94, v10
  v_mul_f32 v95, v95, v10
  v_mul_f32 v96, v96, v10
  v_mul_f32 v97, v97, v10
  v_mul_f32 v98, v98, v10
  v_mul_f32 v99, v99, v10
  v_mul_f32 v100, v100, v10
  v_mul_f32 v101, v101, v10
  v_mul_f32 v102, v102, v10
  v_mul_f32 v103, v103, v10
  v_mul_f32 v104, v104, v10
  v_mul_f32 v105, v105, v10
  v_mul_f32 v106, v106, v10
  v_mul_f32 v107, v107, v10
  v_mul_f32 v108, v108, v10
  v_mul_f32 v109, v109, v10
  v_mul_f32 v110, v110, v10
  v_mul_f32 v111, v111, v10
  v_mul_f32 v112, v112, v10
  v_mul_f32 v113, v113, v10
  v_mul_f32 v114, v114, v10
  v_mul_f32 v115, v115, v10
  v_mul_f32 v116, v116, v10
  v_mul_f32 v117, v117, v10
  v_mul_f32 v118, v118, v10
  v_mul_f32 v119, v119, v10
  v_mul_f32 v120, v120, v10
  v_mul_f32 v121, v121, v10
  v_mul_f32 v122, v122, v10
  v_mul_f32 v123, v123, v10
L_noscale_sh:
  s_waitcnt vmcnt(16)
  v_perm_b32 v8, v196, v188, s53
  v_perm_b32 v9, v212, v204, s53
  v_perm_b32 v10, v228, v220, s53
  v_perm_b32 v11, v244, v236, s53
  s_nop 1
  v_mfma_f32_16x16x32_bf16 v[60:63], v[8:11], v[24:27], v[60:63]
  v_perm_b32 v12, v196, v188, s54
  v_perm_b32 v13, v212, v204, s54
  v_perm_b32 v14, v228, v220, s54
  v_perm_b32 v15, v244, v236, s54
  s_nop 1
  v_mfma_f32_16x16x32_bf16 v[64:67], v[12:15], v[24:27], v[64:67]
  v_perm_b32 v8, v197, v189, s53
  v_perm_b32 v9, v213, v205, s53
  v_perm_b32 v10, v229, v221, s53
  v_perm_b32 v11, v245, v237, s53
  s_nop 1
  v_mfma_f32_16x16x32_bf16 v[68:71], v[8:11], v[24:27], v[68:71]
  v_perm_b32 v12, v197, v189, s54
  v_perm_b32 v13, v213, v205, s54
  v_perm_b32 v14, v229, v221, s54
  v_perm_b32 v15, v245, v237, s54
  s_nop 1
  v_mfma_f32_16x16x32_bf16 v[72:75], v[12:15], v[24:27], v[72:75]
  v_perm_b32 v8, v198, v190, s53
  v_perm_b32 v9, v214, v206, s53
  v_perm_b32 v10, v230, v222, s53
  v_perm_b32 v11, v246, v238, s53
  s_nop 1
  v_mfma_f32_16x16x32_bf16 v[76:79], v[8:11], v[24:27], v[76:79]
  v_perm_b32 v12, v198, v190, s54
  v_perm_b32 v13, v214, v206, s54
  v_perm_b32 v14, v230, v222, s54
  v_perm_b32 v15, v246, v238, s54
  s_nop 1
  v_mfma_f32_16x16x32_bf16 v[80:83], v[12:15], v[24:27], v[80:83]
  v_perm_b32 v8, v199, v191, s53
  v_perm_b32 v9, v215, v207, s53
  v_perm_b32 v10, v231, v223, s53
  v_perm_b32 v11, v247, v239, s53
  s_nop 1
  v_mfma_f32_16x16x32_bf16 v[84:87], v[8:11], v[24:27], v[84:87]
  v_perm_b32 v12, v199, v191, s54
  v_perm_b32 v13, v215, v207, s54
  v_perm_b32 v14, v231, v223, s54
  v_perm_b32 v15, v247, v239, s54
  s_nop 1
  v_mfma_f32_16x16x32_bf16 v[88:91], v[12:15], v[24:27], v[88:91]
  v_perm_b32 v8, v200, v192, s53
  v_perm_b32 v9, v216, v208, s53
  v_perm_b32 v10, v232, v224, s53
  v_perm_b32 v11, v248, v240, s53
  s_nop 1
  v_mfma_f32_16x16x32_bf16 v[92:95], v[8:11], v[24:27], v[92:95]
  v_perm_b32 v12, v200, v192, s54
  v_perm_b32 v13, v216, v208, s54
  v_perm_b32 v14, v232, v224, s54
  v_perm_b32 v15, v248, v240, s54
  s_nop 1
  v_mfma_f32_16x16x32_bf16 v[96:99], v[12:15], v[24:27], v[96:99]
  v_perm_b32 v8, v201, v193, s53
  v_perm_b32 v9, v217, v209, s53
  v_perm_b32 v10, v233, v225, s53
  v_perm_b32 v11, v249, v241, s53
  s_nop 1
  v_mfma_f32_16x16x32_bf16 v[100:103], v[8:11], v[24:27], v[100:103]
  v_perm_b32 v12, v201, v193, s54
  v_perm_b32 v13, v217, v209, s54
  v_perm_b32 v14, v233, v225, s54
  v_perm_b32 v15, v249, v241, s54
  s_nop 1
  v_mfma_f32_16x16x32_bf16 v[104:107], v[12:15], v[24:27], v[104:107]
  v_perm_b32 v8, v202, v194, s53
  v_perm_b32 v9, v218, v210, s53
  v_perm_b32 v10, v234, v226, s53
  v_perm_b32 v11, v250, v242, s53
  s_nop 1
  v_mfma_f32_16x16x32_bf16 v[108:111], v[8:11], v[24:27], v[108:111]
  v_perm_b32 v12, v202, v194, s54
  v_perm_b32 v13, v218, v210, s54
  v_perm_b32 v14, v234, v226, s54
  v_perm_b32 v15, v250, v242, s54
  s_nop 1
  v_mfma_f32_16x16x32_bf16 v[112:115], v[12:15], v[24:27], v[112:115]
  v_perm_b32 v8, v203, v195, s53
  v_perm_b32 v9, v219, v211, s53
  v_perm_b32 v10, v235, v227, s53
  v_perm_b32 v11, v251, v243, s53
  s_nop 1
  v_mfma_f32_16x16x32_bf16 v[116:119], v[8:11], v[24:27], v[116:119]
  v_perm_b32 v12, v203, v195, s54
  v_perm_b32 v13, v219, v211, s54
  v_perm_b32 v14, v235, v227, s54
  v_perm_b32 v15, v251, v243, s54
  s_nop 1
  v_mfma_f32_16x16x32_bf16 v[120:123], v[12:15], v[24:27], v[120:123]
  buffer_load_dwordx4 v[188:191], v2, s[8:11], s44 offen offset:0
  buffer_load_dwordx4 v[192:195], v2, s[8:11], s44 offen offset:256
  buffer_load_dwordx4 v[196:199], v2, s[8:11], s45 offen offset:0
  buffer_load_dwordx4 v[200:203], v2, s[8:11], s45 offen offset:256
  buffer_load_dwordx4 v[204:207], v2, s[8:11], s46 offen offset:0
  buffer_load_dwordx4 v[208:211], v2, s[8:11], s46 offen offset:256
  buffer_load_dwordx4 v[212:215], v2, s[8:11], s47 offen offset:0
  buffer_load_dwordx4 v[216:219], v2, s[8:11], s47 offen offset:256
  buffer_load_dwordx4 v[220:223], v2, s[8:11], s48 offen offset:0
  buffer_load_dwordx4 v[224:227], v2, s[8:11], s48 offen offset:256
  buffer_load_dwordx4 v[228:231], v2, s[8:11], s49 offen offset:0
  buffer_load_dwordx4 v[232:235], v2, s[8:11], s49 offen offset:256
  buffer_load_dwordx4 v[236:239], v2, s[8:11], s50 offen offset:0
  buffer_load_dwordx4 v[240:243], v2, s[8:11], s50 offen offset:256
  buffer_load_dwordx4 v[244:247], v2, s[8:11], s51 offen offset:0
  buffer_load_dwordx4 v[248:251], v2, s[8:11], s51 offen offset:256
  s_mov_b32 s39, s84
  s_mov_b32 s40, s85
  s_cmp_lt_u32 s38, s37
  s_cbranch_scc1 L_loop_sh
  s_branch L_epilogue
L_zero_o:
  v_mov_b32 v60, 0
  v_mov_b32 v61, 0
  v_mov_b32 v62, 0
  v_mov_b32 v63, 0
  v_mov_b32 v64, 0
  v_mov_b32 v65, 0
  v_mov_b32 v66, 0
  v_mov_b32 v67, 0
  v_mov_b32 v68, 0
  v_mov_b32 v69, 0
  v_mov_b32 v70, 0
  v_mov_b32 v71, 0
  v_mov_b32 v72, 0
  v_mov_b32 v73, 0
  v_mov_b32 v74, 0
  v_mov_b32 v75, 0
  v_mov_b32 v76, 0
  v_mov_b32 v77, 0
  v_mov_b32 v78, 0
  v_mov_b32 v79, 0
  v_mov_b32 v80, 0
  v_mov_b32 v81, 0
  v_mov_b32 v82, 0
  v_mov_b32 v83, 0
  v_mov_b32 v84, 0
  v_mov_b32 v85, 0
  v_mov_b32 v86, 0
  v_mov_b32 v87, 0
  v_mov_b32 v88, 0
  v_mov_b32 v89, 0
  v_mov_b32 v90, 0
  v_mov_b32 v91, 0
  v_mov_b32 v92, 0
  v_mov_b32 v93, 0
  v_mov_b32 v94, 0
  v_mov_b32 v95, 0
  v_mov_b32 v96, 0
  v_mov_b32 v97, 0
  v_mov_b32 v98, 0
  v_mov_b32 v99, 0
  v_mov_b32 v100, 0
  v_mov_b32 v101, 0
  v_mov_b32 v102, 0
  v_mov_b32 v103, 0
  v_mov_b32 v104, 0
  v_mov_b32 v105, 0
  v_mov_b32 v106, 0
  v_mov_b32 v107, 0
  v_mov_b32 v108, 0
  v_mov_b32 v109, 0
  v_mov_b32 v110, 0
  v_mov_b32 v111, 0
  v_mov_b32 v112, 0
  v_mov_b32 v113, 0
  v_mov_b32 v114, 0
  v_mov_b32 v115, 0
  v_mov_b32 v116, 0
  v_mov_b32 v117, 0
  v_mov_b32 v118, 0
  v_mov_b32 v119, 0
  v_mov_b32 v120, 0
  v_mov_b32 v121, 0
  v_mov_b32 v122, 0
  v_mov_b32 v123, 0
L_epilogue:
  s_waitcnt vmcnt(0)
  s_nop 15
  v_mov_b32 v8, v7
  s_nop 1
  v_permlane32_swap_b32 v7, v8
  s_nop 1
  v_add_f32 v7, v7, v8
  v_mov_b32 v8, v7
  s_nop 1
  v_permlane16_swap_b32 v7, v8
  s_nop 1
  v_add_f32 v7, v7, v8
  v_and_b32 v8, 63, v0
  v_and_b32 v9, 15, v0
  v_lshrrev_b32 v10, 4, v8
  s_mov_b32 s12, s30
  s_and_b32 s13, s31, 0xffff
  s_mov_b32 s14, 8454144
  s_mov_b32 s15, 0x00020000
  s_cmp_eq_u32 s34, 1
  s_cbranch_scc1 L_epi_sh
  s_cmp_lt_u32 0, s78
  s_cselect_b32 s60, 1.0, 0
  s_cselect_b32 s68, 0, 0xff800000
  s_cmp_lt_u32 1, s78
  s_cselect_b32 s61, 1.0, 0
  s_cselect_b32 s69, 0, 0xff800000
  s_cmp_lt_u32 2, s78
  s_cselect_b32 s62, 1.0, 0
  s_cselect_b32 s70, 0, 0xff800000
  s_cmp_lt_u32 3, s78
  s_cselect_b32 s63, 1.0, 0
  s_cselect_b32 s71, 0, 0xff800000
  s_cmp_lt_u32 4, s78
  s_cselect_b32 s64, 1.0, 0
  s_cselect_b32 s72, 0, 0xff800000
  s_cmp_lt_u32 5, s78
  s_cselect_b32 s65, 1.0, 0
  s_cselect_b32 s73, 0, 0xff800000
  s_cmp_lt_u32 6, s78
  s_cselect_b32 s66, 1.0, 0
  s_cselect_b32 s74, 0, 0xff800000
  v_lshlrev_b32 v12, 2, v0
  v_lshlrev_b32 v13, 2, v8
  ds_write_b32 v12, v6 offset:3072
  s_waitcnt lgkmcnt(0)
  s_barrier
  ds_read_b32 v16, v13 offset:3072
  ds_read_b32 v17, v13 offset:3328
  ds_read_b32 v18, v13 offset:3584
  ds_read_b32 v19, v13 offset:3840
  ds_read_b32 v20, v13 offset:4096
  ds_read_b32 v21, v13 offset:4352
  ds_read_b32 v22, v13 offset:4608
  v_mov_b32 v14, 0xff800000
  v_mov_b32 v24, 0xff800000
  s_waitcnt lgkmcnt(0)
  v_add_f32 v15, s68, v16
  v_max_f32 v14, v14, v15
  s_xor_b32 s55, s68, 0xff800000
  v_add_f32 v15, s55, v16
  v_max_f32 v24, v24, v15
  v_add_f32 v15, s69, v17
  v_max_f32 v14, v14, v15
  s_xor_b32 s55, s69, 0xff800000
  v_add_f32 v15, s55, v17
  v_max_f32 v24, v24, v15
  v_add_f32 v15, s70, v18
  v_max_f32 v14, v14, v15
  s_xor_b32 s55, s70, 0xff800000
  v_add_f32 v15, s55, v18
  v_max_f32 v24, v24, v15
  v_add_f32 v15, s71, v19
  v_max_f32 v14, v14, v15
  s_xor_b32 s55, s71, 0xff800000
  v_add_f32 v15, s55, v19
  v_max_f32 v24, v24, v15
  v_add_f32 v15, s72, v20
  v_max_f32 v14, v14, v15
  s_xor_b32 s55, s72, 0xff800000
  v_add_f32 v15, s55, v20
  v_max_f32 v24, v24, v15
  v_add_f32 v15, s73, v21
  v_max_f32 v14, v14, v15
  s_xor_b32 s55, s73, 0xff800000
  v_add_f32 v15, s55, v21
  v_max_f32 v24, v24, v15
  v_add_f32 v15, s74, v22
  v_max_f32 v14, v14, v15
  s_xor_b32 s55, s74, 0xff800000
  v_add_f32 v15, s55, v22
  v_max_f32 v24, v24, v15
  s_cmp_lt_u32 s32, s78
  s_cselect_b64 vcc, -1, 0
  v_cndmask_b32 v15, v24, v14, vcc
  v_max_f32 v15, 0xff7fffff, v15
  v_mul_f32 v15, s52, v15
  v_fma_f32 v15, v6, s52, -v15
  v_exp_f32 v15, v15
  s_nop 0
  v_mul_f32 v7, v7, v15
  v_mul_f32 v60, v60, v15
  v_mul_f32 v61, v61, v15
  v_mul_f32 v62, v62, v15
  v_mul_f32 v63, v63, v15
  v_mul_f32 v64, v64, v15
  v_mul_f32 v65, v65, v15
  v_mul_f32 v66, v66, v15
  v_mul_f32 v67, v67, v15
  v_mul_f32 v68, v68, v15
  v_mul_f32 v69, v69, v15
  v_mul_f32 v70, v70, v15
  v_mul_f32 v71, v71, v15
  v_mul_f32 v72, v72, v15
  v_mul_f32 v73, v73, v15
  v_mul_f32 v74, v74, v15
  v_mul_f32 v75, v75, v15
  v_mul_f32 v76, v76, v15
  v_mul_f32 v77, v77, v15
  v_mul_f32 v78, v78, v15
  v_mul_f32 v79, v79, v15
  v_mul_f32 v80, v80, v15
  v_mul_f32 v81, v81, v15
  v_mul_f32 v82, v82, v15
  v_mul_f32 v83, v83, v15
  v_mul_f32 v84, v84, v15
  v_mul_f32 v85, v85, v15
  v_mul_f32 v86, v86, v15
  v_mul_f32 v87, v87, v15
  v_mul_f32 v88, v88, v15
  v_mul_f32 v89, v89, v15
  v_mul_f32 v90, v90, v15
  v_mul_f32 v91, v91, v15
  v_mul_f32 v92, v92, v15
  v_mul_f32 v93, v93, v15
  v_mul_f32 v94, v94, v15
  v_mul_f32 v95, v95, v15
  v_mul_f32 v96, v96, v15
  v_mul_f32 v97, v97, v15
  v_mul_f32 v98, v98, v15
  v_mul_f32 v99, v99, v15
  v_mul_f32 v100, v100, v15
  v_mul_f32 v101, v101, v15
  v_mul_f32 v102, v102, v15
  v_mul_f32 v103, v103, v15
  v_mul_f32 v104, v104, v15
  v_mul_f32 v105, v105, v15
  v_mul_f32 v106, v106, v15
  v_mul_f32 v107, v107, v15
  v_mul_f32 v108, v108, v15
  v_mul_f32 v109, v109, v15
  v_mul_f32 v110, v110, v15
  v_mul_f32 v111, v111, v15
  v_mul_f32 v112, v112, v15
  v_mul_f32 v113, v113, v15
  v_mul_f32 v114, v114, v15
  v_mul_f32 v115, v115, v15
  v_mul_f32 v116, v116, v15
  v_mul_f32 v117, v117, v15
  v_mul_f32 v118, v118, v15
  v_mul_f32 v119, v119, v15
  v_mul_f32 v120, v120, v15
  v_mul_f32 v121, v121, v15
  v_mul_f32 v122, v122, v15
  v_mul_f32 v123, v123, v15
  ds_write_b32 v12, v7 offset:5120
  s_lshl_b32 s55, s32, 11
  v_lshl_add_u32 v15, v10, 1, v9
  v_lshlrev_b32 v15, 4, v15
  v_add_u32 v15, s55, v15
  v_cmp_gt_u32 vcc, 2, v9
  s_nop 4
  s_mov_b64 exec, vcc
  ds_write_b128 v15, v[60:63] offset:7424
  ds_write_b128 v15, v[64:67] offset:7552
  ds_write_b128 v15, v[68:71] offset:7680
  ds_write_b128 v15, v[72:75] offset:7808
  ds_write_b128 v15, v[76:79] offset:7936
  ds_write_b128 v15, v[80:83] offset:8064
  ds_write_b128 v15, v[84:87] offset:8192
  ds_write_b128 v15, v[88:91] offset:8320
  ds_write_b128 v15, v[92:95] offset:8448
  ds_write_b128 v15, v[96:99] offset:8576
  ds_write_b128 v15, v[100:103] offset:8704
  ds_write_b128 v15, v[104:107] offset:8832
  ds_write_b128 v15, v[108:111] offset:8960
  ds_write_b128 v15, v[112:115] offset:9088
  ds_write_b128 v15, v[116:119] offset:9216
  ds_write_b128 v15, v[120:123] offset:9344
  s_mov_b64 exec, -1
  s_waitcnt lgkmcnt(0)
  s_barrier
  v_lshlrev_b32 v12, 2, v0
  ds_read_b32 v16, v12 offset:7424
  ds_read_b32 v17, v12 offset:9472
  ds_read_b32 v18, v12 offset:11520
  ds_read_b32 v19, v12 offset:13568
  ds_read_b32 v20, v12 offset:15616
  ds_read_b32 v21, v12 offset:17664
  ds_read_b32 v22, v12 offset:19712
  s_cmp_lg_u32 s32, 0
  s_cbranch_scc1 L_epi_pr1
  ds_read_b32 v124, v12 offset:9216
  ds_read_b32 v125, v12 offset:11264
  ds_read_b32 v126, v12 offset:13312
  ds_read_b32 v127, v12 offset:15360
  ds_read_b32 v128, v12 offset:17408
  ds_read_b32 v129, v12 offset:19456
  ds_read_b32 v130, v12 offset:21504
  ds_read_b32 v132, v13 offset:5120
  ds_read_b32 v133, v13 offset:5376
  ds_read_b32 v134, v13 offset:5632
  ds_read_b32 v135, v13 offset:5888
  ds_read_b32 v136, v13 offset:6144
  ds_read_b32 v137, v13 offset:6400
  ds_read_b32 v138, v13 offset:6656
L_epi_pr1:
  s_lshl_b32 s57, s76, 4
  s_lshl_b32 s55, s33, 1
  s_add_u32 s57, s57, s55
  s_lshl_b32 s57, s57, 4
  s_add_u32 s57, s57, s79
  s_lshl_b32 s57, s57, 10
  s_lshl_b32 s58, s77, 4
  s_xor_b32 s55, s33, 1
  s_lshl_b32 s55, s55, 1
  s_add_u32 s58, s58, s55
  s_lshl_b32 s58, s58, 4
  s_add_u32 s58, s58, s79
  s_lshl_b32 s58, s58, 10
  v_lshrrev_b32 v188, 5, v0
  v_bfe_u32 v189, v0, 2, 3
  v_and_b32 v190, 3, v0
  v_lshrrev_b32 v191, 3, v188
  v_lshlrev_b32 v191, 7, v191
  v_and_b32 v188, 7, v188
  v_add_u32 v191, v191, v188
  v_lshl_add_u32 v191, v190, 3, v191
  v_lshrrev_b32 v188, 1, v189
  v_lshl_add_u32 v191, v188, 5, v191
  v_and_b32 v189, 1, v189
  v_lshlrev_b32 v189, 14, v189
  v_lshl_add_u32 v192, v191, 2, v189
  s_waitcnt lgkmcnt(0)
  v_mov_b32 v194, 0
  v_mov_b32 v195, 0
  v_fma_f32 v194, v16, s60, v194
  s_xor_b32 s55, s60, 0x3f800000
  v_fma_f32 v195, v16, s55, v195
  v_fma_f32 v194, v17, s61, v194
  s_xor_b32 s55, s61, 0x3f800000
  v_fma_f32 v195, v17, s55, v195
  v_fma_f32 v194, v18, s62, v194
  s_xor_b32 s55, s62, 0x3f800000
  v_fma_f32 v195, v18, s55, v195
  v_fma_f32 v194, v19, s63, v194
  s_xor_b32 s55, s63, 0x3f800000
  v_fma_f32 v195, v19, s55, v195
  v_fma_f32 v194, v20, s64, v194
  s_xor_b32 s55, s64, 0x3f800000
  v_fma_f32 v195, v20, s55, v195
  v_fma_f32 v194, v21, s65, v194
  s_xor_b32 s55, s65, 0x3f800000
  v_fma_f32 v195, v21, s55, v195
  v_fma_f32 v194, v22, s66, v194
  s_xor_b32 s55, s66, 0x3f800000
  v_fma_f32 v195, v22, s55, v195
  buffer_store_dword v194, v192, s[12:15], s57 offen
  buffer_store_dword v195, v192, s[12:15], s58 offen
  s_cmp_lg_u32 s32, 0
  s_cbranch_scc1 L_epi_done
  v_add_u32 v12, 448, v8
  v_lshrrev_b32 v188, 5, v12
  v_bfe_u32 v189, v12, 2, 3
  v_and_b32 v190, 3, v12
  v_lshrrev_b32 v191, 3, v188
  v_lshlrev_b32 v191, 7, v191
  v_and_b32 v188, 7, v188
  v_add_u32 v191, v191, v188
  v_lshl_add_u32 v191, v190, 3, v191
  v_lshrrev_b32 v188, 1, v189
  v_lshl_add_u32 v191, v188, 5, v191
  v_and_b32 v189, 1, v189
  v_lshlrev_b32 v189, 14, v189
  v_lshl_add_u32 v193, v191, 2, v189
  v_mov_b32 v196, 0
  v_mov_b32 v197, 0
  v_fma_f32 v196, v124, s60, v196
  s_xor_b32 s55, s60, 0x3f800000
  v_fma_f32 v197, v124, s55, v197
  v_fma_f32 v196, v125, s61, v196
  s_xor_b32 s55, s61, 0x3f800000
  v_fma_f32 v197, v125, s55, v197
  v_fma_f32 v196, v126, s62, v196
  s_xor_b32 s55, s62, 0x3f800000
  v_fma_f32 v197, v126, s55, v197
  v_fma_f32 v196, v127, s63, v196
  s_xor_b32 s55, s63, 0x3f800000
  v_fma_f32 v197, v127, s55, v197
  v_fma_f32 v196, v128, s64, v196
  s_xor_b32 s55, s64, 0x3f800000
  v_fma_f32 v197, v128, s55, v197
  v_fma_f32 v196, v129, s65, v196
  s_xor_b32 s55, s65, 0x3f800000
  v_fma_f32 v197, v129, s55, v197
  v_fma_f32 v196, v130, s66, v196
  s_xor_b32 s55, s66, 0x3f800000
  v_fma_f32 v197, v130, s55, v197
  buffer_store_dword v196, v193, s[12:15], s57 offen
  buffer_store_dword v197, v193, s[12:15], s58 offen
  v_mov_b32 v15, 0
  v_mov_b32 v25, 0
  v_fma_f32 v15, v132, s60, v15
  s_xor_b32 s55, s60, 0x3f800000
  v_fma_f32 v25, v132, s55, v25
  v_fma_f32 v15, v133, s61, v15
  s_xor_b32 s55, s61, 0x3f800000
  v_fma_f32 v25, v133, s55, v25
  v_fma_f32 v15, v134, s62, v15
  s_xor_b32 s55, s62, 0x3f800000
  v_fma_f32 v25, v134, s55, v25
  v_fma_f32 v15, v135, s63, v15
  s_xor_b32 s55, s63, 0x3f800000
  v_fma_f32 v25, v135, s55, v25
  v_fma_f32 v15, v136, s64, v15
  s_xor_b32 s55, s64, 0x3f800000
  v_fma_f32 v25, v136, s55, v25
  v_fma_f32 v15, v137, s65, v15
  s_xor_b32 s55, s65, 0x3f800000
  v_fma_f32 v25, v137, s55, v25
  v_fma_f32 v15, v138, s66, v15
  s_xor_b32 s55, s66, 0x3f800000
  v_fma_f32 v25, v138, s55, v25
  v_lshlrev_b32 v12, 7, v8
  s_lshr_b32 s57, s57, 7
  s_lshr_b32 s58, s58, 7
  s_add_u32 s57, s57, 8388608
  s_add_u32 s58, s58, 8388608
  s_mov_b64 exec, 3
  buffer_store_dwordx2 v[14:15], v12, s[12:15], s57 offen
  buffer_store_dwordx2 v[24:25], v12, s[12:15], s58 offen
  s_branch L_epi_done
L_epi_sh:
  v_lshrrev_b32 v11, 1, v9
  s_lshl_b32 s55, s35, 3
  v_add_u32 v11, s55, v11
  v_and_b32 v14, 1, v9
  v_lshl_add_u32 v14, v11, 4, v14
  s_lshl_b32 s55, s3, 1
  v_add_u32 v14, s55, v14
  v_lshlrev_b32 v14, 4, v14
  v_add_u32 v14, s94, v14
  v_lshlrev_b32 v15, 10, v14
  v_lshl_add_u32 v15, v10, 7, v15
  v_lshlrev_b32 v14, 3, v14
  v_add_u32 v14, 8388608, v14
  v_mov_b32 v124, v60
  v_mov_b32 v125, v64
  v_mov_b32 v126, v68
  v_mov_b32 v127, v72
  v_mov_b32 v128, v76
  v_mov_b32 v129, v80
  v_mov_b32 v130, v84
  v_mov_b32 v131, v88
  v_mov_b32 v132, v61
  v_mov_b32 v133, v65
  v_mov_b32 v134, v69
  v_mov_b32 v135, v73
  v_mov_b32 v136, v77
  v_mov_b32 v137, v81
  v_mov_b32 v138, v85
  v_mov_b32 v139, v89
  v_mov_b32 v140, v62
  v_mov_b32 v141, v66
  v_mov_b32 v142, v70
  v_mov_b32 v143, v74
  v_mov_b32 v144, v78
  v_mov_b32 v145, v82
  v_mov_b32 v146, v86
  v_mov_b32 v147, v90
  v_mov_b32 v148, v63
  v_mov_b32 v149, v67
  v_mov_b32 v150, v71
  v_mov_b32 v151, v75
  v_mov_b32 v152, v79
  v_mov_b32 v153, v83
  v_mov_b32 v154, v87
  v_mov_b32 v155, v91
  v_mov_b32 v156, v92
  v_mov_b32 v157, v96
  v_mov_b32 v158, v100
  v_mov_b32 v159, v104
  v_mov_b32 v160, v108
  v_mov_b32 v161, v112
  v_mov_b32 v162, v116
  v_mov_b32 v163, v120
  v_mov_b32 v164, v93
  v_mov_b32 v165, v97
  v_mov_b32 v166, v101
  v_mov_b32 v167, v105
  v_mov_b32 v168, v109
  v_mov_b32 v169, v113
  v_mov_b32 v170, v117
  v_mov_b32 v171, v121
  v_mov_b32 v172, v94
  v_mov_b32 v173, v98
  v_mov_b32 v174, v102
  v_mov_b32 v175, v106
  v_mov_b32 v176, v110
  v_mov_b32 v177, v114
  v_mov_b32 v178, v118
  v_mov_b32 v179, v122
  v_mov_b32 v180, v95
  v_mov_b32 v181, v99
  v_mov_b32 v182, v103
  v_mov_b32 v183, v107
  v_mov_b32 v184, v111
  v_mov_b32 v185, v115
  v_mov_b32 v186, v119
  v_mov_b32 v187, v123
  buffer_store_dwordx4 v[124:127], v15, s[12:15], 0 offen offset:0
  buffer_store_dwordx4 v[128:131], v15, s[12:15], 0 offen offset:16
  buffer_store_dwordx4 v[132:135], v15, s[12:15], 0 offen offset:32
  buffer_store_dwordx4 v[136:139], v15, s[12:15], 0 offen offset:48
  buffer_store_dwordx4 v[140:143], v15, s[12:15], 0 offen offset:64
  buffer_store_dwordx4 v[144:147], v15, s[12:15], 0 offen offset:80
  buffer_store_dwordx4 v[148:151], v15, s[12:15], 0 offen offset:96
  buffer_store_dwordx4 v[152:155], v15, s[12:15], 0 offen offset:112
  buffer_store_dwordx4 v[156:159], v15, s[12:15], 0 offen offset:512
  buffer_store_dwordx4 v[160:163], v15, s[12:15], 0 offen offset:528
  buffer_store_dwordx4 v[164:167], v15, s[12:15], 0 offen offset:544
  buffer_store_dwordx4 v[168:171], v15, s[12:15], 0 offen offset:560
  buffer_store_dwordx4 v[172:175], v15, s[12:15], 0 offen offset:576
  buffer_store_dwordx4 v[176:179], v15, s[12:15], 0 offen offset:592
  buffer_store_dwordx4 v[180:183], v15, s[12:15], 0 offen offset:608
  buffer_store_dwordx4 v[184:187], v15, s[12:15], 0 offen offset:624
  v_mov_b32 v12, v6
  v_mov_b32 v13, v7
  s_mov_b64 exec, 0xffff
  buffer_store_dwordx2 v[12:13], v14, s[12:15], 0 offen
  s_mov_b64 exec, -1
  s_barrier
  s_barrier
L_epi_done:
L_main_end:
  s_endpgm
.globl combine_kernel
.p2align 8
.type combine_kernel,@function
combine_kernel:
  s_cmp_ge_u32 s2, 128
  s_cbranch_scc1 L_cmb_end
  s_load_dwordx16 s[16:31], s[0:1], 0
  v_lshrrev_b32 v1, 6, v0
  v_and_b32 v2, 63, v0
  s_nop 0
  v_readfirstlane_b32 s3, v1
  s_lshl_b32 s4, s2, 2
  s_nop 2
  s_add_u32 s4, s4, s3
  s_mov_b32 s56, 0x3db8aa3b
  s_waitcnt lgkmcnt(0)
  s_lshl_b32 s5, s4, 7
  s_add_u32 s5, s5, 8388608
  s_load_dwordx16 s[32:47], s[30:31], s5
  s_add_u32 s5, s5, 64
  s_load_dwordx4 s[48:51], s[30:31], s5
  s_lshr_b32 s6, s4, 4
  s_lshl_b32 s7, s6, 2
  s_load_dword s52, s[24:25], s7
  s_mov_b32 s8, s30
  s_and_b32 s9, s31, 0xffff
  s_mov_b32 s10, 8454144
  s_mov_b32 s11, 0x00020000
  s_lshl_b32 s12, s4, 14
  s_add_u32 s13, s12, 4096
  s_add_u32 s14, s12, 8192
  v_lshlrev_b32 v3, 4, v2
  buffer_load_dwordx4 v[8:11], v3, s[8:11], s12 offen offset:0
  buffer_load_dwordx4 v[12:15], v3, s[8:11], s12 offen offset:1024
  buffer_load_dwordx4 v[16:19], v3, s[8:11], s12 offen offset:2048
  buffer_load_dwordx4 v[20:23], v3, s[8:11], s12 offen offset:3072
  buffer_load_dwordx4 v[24:27], v3, s[8:11], s13 offen offset:0
  buffer_load_dwordx4 v[28:31], v3, s[8:11], s13 offen offset:1024
  buffer_load_dwordx4 v[32:35], v3, s[8:11], s13 offen offset:2048
  buffer_load_dwordx4 v[36:39], v3, s[8:11], s13 offen offset:3072
  buffer_load_dwordx4 v[40:43], v3, s[8:11], s14 offen offset:0
  buffer_load_dwordx4 v[44:47], v3, s[8:11], s14 offen offset:1024
  s_waitcnt lgkmcnt(0)
  v_mov_b32 v4, s32
  v_max_f32 v4, s34, v4
  v_max_f32 v4, s36, v4
  v_max_f32 v4, s38, v4
  v_max_f32 v4, s40, v4
  v_max_f32 v4, s42, v4
  v_max_f32 v4, s44, v4
  v_max_f32 v4, s46, v4
  v_max_f32 v4, s48, v4
  v_max_f32 v4, s50, v4
  s_max_i32 s52, s52, 0
  s_min_i32 s52, s52, 2048
  s_sub_u32 s53, 2048, s52
  s_mov_b32 s54, 0
  s_cmp_eq_u32 s53, 0
  s_cbranch_scc1 L_cmb_fast
  v_cmp_gt_f32 vcc, 0xd06dfffe, v4
  s_nop 4
  s_cbranch_vccz L_cmb_fast
  s_mov_b32 s54, 1
  v_max_f32 v4, 0xd06e0000, v4
L_cmb_fast:
  v_max_f32 v4, 0xff7fffff, v4
  v_mul_f32 v5, s56, v4
  v_mov_b32 v6, 0
  v_mov_b32 v48, 0
  v_mov_b32 v49, 0
  v_mov_b32 v50, 0
  v_mov_b32 v51, 0
  s_waitcnt vmcnt(0)
  v_mov_b32 v7, s32
  v_fma_f32 v7, v7, s56, -v5
  v_exp_f32 v7, v7
  s_nop 0
  v_fma_f32 v6, v7, s33, v6
  v_fma_f32 v48, v7, v8, v48
  v_fma_f32 v49, v7, v9, v49
  v_fma_f32 v50, v7, v10, v50
  v_fma_f32 v51, v7, v11, v51
  v_mov_b32 v7, s34
  v_fma_f32 v7, v7, s56, -v5
  v_exp_f32 v7, v7
  s_nop 0
  v_fma_f32 v6, v7, s35, v6
  v_fma_f32 v48, v7, v12, v48
  v_fma_f32 v49, v7, v13, v49
  v_fma_f32 v50, v7, v14, v50
  v_fma_f32 v51, v7, v15, v51
  v_mov_b32 v7, s36
  v_fma_f32 v7, v7, s56, -v5
  v_exp_f32 v7, v7
  s_nop 0
  v_fma_f32 v6, v7, s37, v6
  v_fma_f32 v48, v7, v16, v48
  v_fma_f32 v49, v7, v17, v49
  v_fma_f32 v50, v7, v18, v50
  v_fma_f32 v51, v7, v19, v51
  v_mov_b32 v7, s38
  v_fma_f32 v7, v7, s56, -v5
  v_exp_f32 v7, v7
  s_nop 0
  v_fma_f32 v6, v7, s39, v6
  v_fma_f32 v48, v7, v20, v48
  v_fma_f32 v49, v7, v21, v49
  v_fma_f32 v50, v7, v22, v50
  v_fma_f32 v51, v7, v23, v51
  v_mov_b32 v7, s40
  v_fma_f32 v7, v7, s56, -v5
  v_exp_f32 v7, v7
  s_nop 0
  v_fma_f32 v6, v7, s41, v6
  v_fma_f32 v48, v7, v24, v48
  v_fma_f32 v49, v7, v25, v49
  v_fma_f32 v50, v7, v26, v50
  v_fma_f32 v51, v7, v27, v51
  v_mov_b32 v7, s42
  v_fma_f32 v7, v7, s56, -v5
  v_exp_f32 v7, v7
  s_nop 0
  v_fma_f32 v6, v7, s43, v6
  v_fma_f32 v48, v7, v28, v48
  v_fma_f32 v49, v7, v29, v49
  v_fma_f32 v50, v7, v30, v50
  v_fma_f32 v51, v7, v31, v51
  v_mov_b32 v7, s44
  v_fma_f32 v7, v7, s56, -v5
  v_exp_f32 v7, v7
  s_nop 0
  v_fma_f32 v6, v7, s45, v6
  v_fma_f32 v48, v7, v32, v48
  v_fma_f32 v49, v7, v33, v49
  v_fma_f32 v50, v7, v34, v50
  v_fma_f32 v51, v7, v35, v51
  v_mov_b32 v7, s46
  v_fma_f32 v7, v7, s56, -v5
  v_exp_f32 v7, v7
  s_nop 0
  v_fma_f32 v6, v7, s47, v6
  v_fma_f32 v48, v7, v36, v48
  v_fma_f32 v49, v7, v37, v49
  v_fma_f32 v50, v7, v38, v50
  v_fma_f32 v51, v7, v39, v51
  v_mov_b32 v7, s48
  v_fma_f32 v7, v7, s56, -v5
  v_exp_f32 v7, v7
  s_nop 0
  v_fma_f32 v6, v7, s49, v6
  v_fma_f32 v48, v7, v40, v48
  v_fma_f32 v49, v7, v41, v49
  v_fma_f32 v50, v7, v42, v50
  v_fma_f32 v51, v7, v43, v51
  v_mov_b32 v7, s50
  v_fma_f32 v7, v7, s56, -v5
  v_exp_f32 v7, v7
  s_nop 0
  v_fma_f32 v6, v7, s51, v6
  v_fma_f32 v48, v7, v44, v48
  v_fma_f32 v49, v7, v45, v49
  v_fma_f32 v50, v7, v46, v50
  v_fma_f32 v51, v7, v47, v51
  s_cmp_eq_u32 s54, 0
  s_cbranch_scc1 L_cmb_out
  v_mov_b32 v7, 0xd06e0000
  v_fma_f32 v7, v7, s56, -v5
  v_exp_f32 v7, v7
  v_cvt_f32_u32 v52, s53
  v_fma_f32 v6, v7, v52, v6
  s_mov_b32 s8, s20
  s_and_b32 s9, s21, 0xffff
  s_mov_b32 s10, 138412032
  s_mov_b32 s11, 0x00020000
  s_and_b32 s13, s4, 15
  s_lshr_b32 s13, s13, 1
  s_lshl_b32 s13, s13, 9
  v_lshlrev_b32 v3, 3, v2
  v_mov_b32 v54, 0
  v_mov_b32 v55, 0
  v_mov_b32 v56, 0
  v_mov_b32 v57, 0
L_cmb_slow:
  s_lshr_b32 s14, s52, 4
  s_lshl_b32 s14, s14, 2
  s_lshl_b32 s15, s6, 9
  s_add_u32 s14, s14, s15
  s_load_dword s15, s[22:23], s14
  s_waitcnt lgkmcnt(0)
  s_lshl_b32 s15, s15, 16
  s_and_b32 s14, s52, 15
  s_lshl_b32 s14, s14, 12
  s_add_u32 s15, s15, s14
  s_add_u32 s15, s15, s13
  buffer_load_dwordx2 v[58:59], v3, s[8:11], s15 offen
  s_waitcnt vmcnt(0)
  v_lshlrev_b32 v60, 16, v58
  v_and_b32 v61, 0xffff0000, v58
  v_lshlrev_b32 v62, 16, v59
  v_and_b32 v63, 0xffff0000, v59
  v_add_f32 v54, v54, v60
  v_add_f32 v55, v55, v61
  v_add_f32 v56, v56, v62
  v_add_f32 v57, v57, v63
  s_add_u32 s52, s52, 1
  s_cmp_lt_u32 s52, 2048
  s_cbranch_scc1 L_cmb_slow
  v_fma_f32 v48, v7, v54, v48
  v_fma_f32 v49, v7, v55, v49
  v_fma_f32 v50, v7, v56, v50
  v_fma_f32 v51, v7, v57, v51
L_cmb_out:
  v_rcp_f32 v6, v6
  s_nop 0
  v_mul_f32 v48, v48, v6
  v_mul_f32 v49, v49, v6
  v_mul_f32 v50, v50, v6
  v_mul_f32 v51, v51, v6
  v_cvt_pk_bf16_f32 v52, v48, v49
  v_cvt_pk_bf16_f32 v53, v50, v51
  s_mov_b32 s8, s26
  s_and_b32 s9, s27, 0xffff
  s_mov_b32 s10, 262144
  s_mov_b32 s11, 0x00020000
  s_lshl_b32 s12, s4, 9
  v_lshlrev_b32 v3, 3, v2
  buffer_store_dwordx2 v[52:53], v3, s[8:11], s12 offen
L_cmb_end:
  s_endpgm
.section .rodata,"a"
.p2align 6
.amdhsa_kernel standalone__paged_block_table_kv_radixattention__sampling_kernel
  .amdhsa_next_free_vgpr 252
  .amdhsa_next_free_sgpr 96
  .amdhsa_accum_offset 252
  .amdhsa_group_segment_fixed_size 0
  .amdhsa_kernarg_size 64
  .amdhsa_user_sgpr_count 2
  .amdhsa_user_sgpr_kernarg_segment_ptr 1
  .amdhsa_system_sgpr_workgroup_id_x 1
  .amdhsa_float_denorm_mode_32 3
.end_amdhsa_kernel
.p2align 6
.amdhsa_kernel combine_kernel
  .amdhsa_next_free_vgpr 64
  .amdhsa_next_free_sgpr 60
  .amdhsa_accum_offset 64
  .amdhsa_group_segment_fixed_size 0
  .amdhsa_kernarg_size 64
  .amdhsa_user_sgpr_count 2
  .amdhsa_user_sgpr_kernarg_segment_ptr 1
  .amdhsa_system_sgpr_workgroup_id_x 1
  .amdhsa_float_denorm_mode_32 3
.end_amdhsa_kernel
```
